```python
import torch

def _softmax(x, axis=-1):
    return torch.softmax(x, dim=axis)
def _gelu(x):
    return torch.nn.functional.gelu(x, approximate="tanh")
def _silu(x):
    return torch.nn.functional.silu(x)
def _sigmoid(x):
    return torch.sigmoid(x)
def _layernorm(x, axis=-1, eps=1e-5):
    m = x.mean(dim=axis, keepdim=True)
    v = x.var(dim=axis, keepdim=True, unbiased=False)
    return (x - m) / torch.sqrt(v + eps)
def _scatter_add(tgt, idx, src, axis=0):
    return tgt.clone().index_add_(axis, idx, src)
def _segment_sum(src, seg, n):
    out = torch.zeros((n,) + src.shape[1:], dtype=src.dtype)
    return out.index_add_(0, seg, src)
def _pad(x, pw):
    flat = tuple(v for pair in reversed(pw) for v in pair)
    return torch.nn.functional.pad(x, flat)

kernel_name = 'recurrent_scan__softmax_full_mha__dense_activation_squared_relu__prompt'

def setup_inputs():

    _w = (lambda a: (lambda t: t.to(torch.bfloat16) if t.is_floating_point() else t)(torch.as_tensor(a)))
    def _A_setup():
        B, S, D = 1, 2048, 512
        return {
            "x": _w((lambda *s: torch.randn(*s, dtype=torch.bfloat16) * 0.05)(B, S, D)),
            "wqkv": _w((lambda *s: torch.randn(*s, dtype=torch.bfloat16) * 0.05)(D, 3 * D)),
            "wo": _w((lambda *s: torch.randn(*s, dtype=torch.bfloat16) * 0.05)(D, D)),
        }
    _A_in = _A_setup()

    def _B_setup():
        B, S, D, F = 1, 2048, 512, 1376
        return {
            "x": _w((lambda *s: torch.randn(*s, dtype=torch.bfloat16) * 0.05)(B, S, D)),
            "w1": _w((lambda *s: torch.randn(*s, dtype=torch.bfloat16) * 0.05)(D, F)),
            "b1": _w((lambda *s: torch.randn(*s, dtype=torch.bfloat16) * 0.8)(F)),
            "w2": _w((lambda *s: torch.randn(*s, dtype=torch.bfloat16) * 0.05)(F, D)),
            "b2": _w((lambda *s: torch.randn(*s, dtype=torch.bfloat16) * 1.6)(D)),
        }
    _B_in = _B_setup()

    return {
        "A_x": _A_in["x"],
        "A_wqkv": _A_in["wqkv"],
        "A_wo": _A_in["wo"],
        "B_x": _B_in["x"],
        "B_w1": _B_in["w1"],
        "B_b1": _B_in["b1"],
        "B_w2": _B_in["w2"],
        "B_b2": _B_in["b2"],
    }

def reference(A_x, A_wqkv, A_wo, B_x, B_w1, B_b1, B_w2, B_b2):
    def _A_ref(x, wqkv, wo):
        B, S, D = x.shape
        H = 32; Dh = D // H
        qkv = (lambda x, *d: x.permute(*d))((x @ wqkv).reshape(B, S, 3, H, Dh), 2, 0, 3, 1, 4)
        q, k, v = qkv[0], qkv[1], qkv[2]
        scale = Dh ** -0.5
        scores = torch.einsum("bhqd,bhkd->bhqk", q, k) * scale
        p = _softmax(scores, axis=-1)
        o = torch.einsum("bhqk,bhkd->bhqd", p, v)
        return (lambda x, *d: x.permute(*d))(o, 0, 2, 1, 3).reshape(B, S, D) @ wo

    def _B_ref(x, w1, b1, w2, b2):
        h = torch.einsum("bsd,df->bsf", x, w1) + b1
        zero = torch.zeros_like(h)
        r = torch.where(h > zero, h, zero)
        h = r * r
        out = torch.einsum("bsf,fd->bsd", h, w2) + b2
        return out

    x = A_x
    xn = _layernorm(x, axis=-1)
    s = _A_ref(xn, A_wqkv, A_wo)
    g = _silu(_B_ref(xn, B_w1, B_b1, B_w2, B_b2))
    return x + s * g
```

```asm
; @launch grid=(256,1,1) block=(512,1,1) lds=163840
.amdgcn_target "amdgcn-amd-amdhsa--gfx950"
.text
.globl recurrent_scan__softmax_full_mha__dense_activation_squared_relu__prompt_kernel
.p2align 8
.type recurrent_scan__softmax_full_mha__dense_activation_squared_relu__prompt_kernel,@function
recurrent_scan__softmax_full_mha__dense_activation_squared_relu__prompt_kernel:
    s_load_dwordx2 s[24:25], s[0:1], 0
    s_getpc_b64 s[72:73]
L_pc:
    s_cmpk_ge_u32 s2, 256
    s_cbranch_scc1 L_end
    s_lshr_b32 s74, s2, 3
    s_lshl_b32 s74, s74, 11
    v_lshrrev_b32 v8, 5, v0
    v_lshl_add_u32 v8, v8, 7, s74
    v_min_u32 v8, L_code_end-L_pc, v8
    v_mov_b32 v9, 0
    v_lshl_add_u64 v[8:9], v[8:9], 0, s[72:73]
    global_load_dword v7, v[8:9], off
    s_lshl_b32 s72, s2, 4
    s_and_b32 s72, s72, 0x180
    v_add_u32 v4, s72, v0
    v_bfe_u32 v4, v4, 3, 6
    v_and_b32 v5, 7, v0
    v_lshlrev_b32 v14, 10, v4
    v_lshl_add_u32 v14, v5, 4, v14
    s_lshr_b32 s67, s2, 5
    s_and_b32 s73, s2, 6
    s_lshl2_add_u32 s62, s73, s67
    s_lshl_b32 s101, s62, 16
    s_mov_b32 s26, 2097152
    s_mov_b32 s27, 0x20000
    v_bfe_u32 v24, v4, 1, 3
    v_xor_b32 v24, v24, v5
    v_lshlrev_b32 v15, 7, v4
    v_lshl_add_u32 v15, v24, 4, v15
    v_readfirstlane_b32 s60, v0
    v_and_b32 v0, 63, v0
    v_and_b32 v26, 3, v0
    v_mov_b32 v29, 0
    s_lshr_b32 s60, s60, 6
    s_cmp_ge_u32 s60, 4
    s_waitcnt lgkmcnt(0)
    buffer_load_dwordx4 v[128:131], v14, s[24:27], s101 offen offset:0
    buffer_load_dwordx4 v[132:135], v14, s[24:27], s101 offen offset:128
    buffer_load_dwordx4 v[136:139], v14, s[24:27], s101 offen offset:256
    buffer_load_dwordx4 v[140:143], v14, s[24:27], s101 offen offset:384
    buffer_load_dwordx4 v[144:147], v14, s[24:27], s101 offen offset:512
    buffer_load_dwordx4 v[148:151], v14, s[24:27], s101 offen offset:640
    buffer_load_dwordx4 v[152:155], v14, s[24:27], s101 offen offset:768
    buffer_load_dwordx4 v[156:159], v14, s[24:27], s101 offen offset:896
    s_mov_b32 s63, 1
    s_cbranch_scc1 L_ln
    s_mov_b32 s63, 0
    s_load_dwordx2 s[28:29], s[0:1], 8
    s_load_dwordx2 s[56:57], s[0:1], 80
    s_load_dwordx2 s[36:37], s[0:1], 32
    s_load_dwordx2 s[40:41], s[0:1], 40
    s_load_dwordx2 s[32:33], s[0:1], 16
    s_load_dwordx2 s[44:45], s[0:1], 48
    s_load_dwordx2 s[48:49], s[0:1], 56
    s_load_dwordx2 s[52:53], s[0:1], 64
    s_mov_b32 s30, 1572864
    s_mov_b32 s31, 0x20000
    s_bfe_u32 s72, s2, 0x20003
    s_and_b32 s73, s2, 1
    s_lshl2_add_u32 s61, s73, s72
    s_and_b32 s74, s60, 3
    s_lshl_b32 s72, s61, 7
    s_mul_i32 s85, s74, 49152
    s_add_u32 s85, s85, s72
    s_mul_i32 s87, s74, 6144
    s_add_u32 s87, s87, 65536
    v_lshrrev_b32 v4, 3, v0
    v_bfe_u32 v6, v4, 1, 1
    v_lshlrev_b32 v6, 2, v6
    v_xor_b32 v6, v6, v5
    v_lshlrev_b32 v6, 4, v6
    v_mul_u32_u24 v13, 3072, v4
    v_add_u32 v13, v13, v6
    v_xor_b32 v33, 16, v13
    s_waitcnt lgkmcnt(0)
    s_mov_b32 s34, 524288
    s_mov_b32 s35, 0x20000
    s_mov_b32 s46, 1409024
    s_mov_b32 s47, 0x20000
    s_and_b32 s73, s60, 3
    s_lshl1_add_u32 s100, s2, s73
    s_mul_i32 s100, s100, 2816
    s_bitcmp1_b32 s2, 0
    s_cselect_b32 s100, 0x40000000, s100
    v_min_u32 v31, 21, v0
    v_lshlrev_b32 v31, 7, v31
    s_load_dword s68, s[56:57], 0
    s_mov_b32 s58, 12976128
    s_mov_b32 s59, 0x20000
    s_mov_b32 s42, 2752
    s_mov_b32 s43, 0x20000
    s_mov_b32 s50, 1024
    s_mov_b32 s51, 0x20000
    s_mov_b32 s54, 2097152
    s_mov_b32 s55, 0x20000
    s_bfe_u32 s72, s2, 0x20003
    s_and_b32 s73, s2, 7
    s_lshl2_add_u32 s66, s73, s72
    s_and_b32 s72, s72, 1
    s_and_b32 s64, s2, 6
    s_add_u32 s72, s72, s64
    s_and_b32 s64, s2, 1
    s_lshl3_add_u32 s64, s64, s72
    s_lshr_b32 s65, s2, 4
    s_mul_i32 s69, s61, 6
    s_mul_i32 s73, s61, 5
    s_add_u32 s73, s73, 3
    s_min_u32 s69, s69, s73
    s_mov_b32 s70, 0xffff
    s_mov_b32 s71, 0xffff
    v_lshlrev_b32 v1, 4, v0
    v_and_b32 v2, 15, v0
    v_lshrrev_b32 v3, 5, v0
    v_lshl_add_u32 v2, v3, 4, v2
    v_lshlrev_b32 v2, 4, v2
    s_and_b32 s74, s60, 1
    s_lshr_b32 s75, s60, 1
    v_bfe_u32 v9, v0, 4, 1
    v_and_b32 v16, 15, v0
    v_lshlrev_b32 v8, 4, v16
    v_lshl_add_u32 v8, v9, 9, v8
    v_lshl_add_u32 v11, v3, 17, v8
    v_lshl_add_u32 v14, v3, 10, v8
    v_lshl_add_u32 v127, v3, 16, v8
    v_lshrrev_b32 v17, 4, v0
    v_bfe_u32 v8, v0, 3, 1
    v_lshlrev_b32 v12, 4, v5
    v_lshl_add_u32 v12, v17, 8, v12
    v_lshl_add_u32 v12, v8, 17, v12
    v_lshrrev_b32 v8, 1, v16
    v_xor_b32 v8, v8, v17
    v_lshlrev_b32 v16, 7, v16
    v_lshl_add_u32 v16, v8, 4, v16
    s_lshl_b32 s72, s74, 12
    v_add_u32 v16, s72, v16
    v_xor_b32 v17, 64, v16
    v_mov_b32 v125, v31
    v_and_b32 v126, 6, v4
    v_xor_b32 v126, v126, v5
    v_lshlrev_b32 v126, 4, v126
    v_lshl_add_u32 v126, v4, 10, v126
    v_lshl_add_u32 v4, v4, 10, v6
    v_bfe_u32 v10, v0, 2, 2
    v_lshrrev_b32 v6, 1, v10
    v_xor_b32 v8, s75, v6
    v_and_b32 v18, 2, v0
    v_lshl_add_u32 v8, v8, 2, v18
    v_add_u32 v8, v8, v9
    v_lshlrev_b32 v8, 1, v8
    v_and_or_b32 v8, v0, 1, v8
    v_lshlrev_b32 v8, 3, v8
    v_lshl_add_u32 v8, v10, 7, v8
    v_lshl_add_u32 v8, v9, 10, v8
    v_mul_u32_u24 v18, 6144, v3
    v_add_u32 v8, v8, v18
    v_add_u32 v8, 65536, v8
    v_xor_b32 v18, 16, v8
    v_add_u32 v19, 49152, v18
    v_lshlrev_b32 v5, 5, v9
    v_lshl_add_u32 v5, v10, 7, v5
    v_and_b32 v10, 3, v0
    v_lshl_add_u32 v5, v10, 3, v5
    v_lshl_add_u32 v5, v3, 9, v5
    v_lshl_add_u32 v5, v6, 6, v5
    v_lshrrev_b32 v10, 1, v0
    v_xor_b32 v10, v10, v0
    v_and_b32 v10, 1, v10
    v_mul_u32_u24 v10, 24, v10
    v_xor_b32 v5, v5, v10
    s_mul_i32 s84, s60, 10240
    s_add_u32 s84, s84, 120832
    v_add_u32 v5, s84, v5
    v_xor_b32 v6, 64, v5
    v_lshlrev_b32 v10, 3, v9
    v_lshl_add_u32 v10, v3, 5, v10
    v_xor_b32 v9, 16, v19
    v_mov_b32 v3, 0xdddddddd
L_ln:
    v_mov_b32 v232, 0x3f803f80
    v_mov_b32 v233, 0x3f803f80
    v_lshlrev_b32 v26, 4, v26
    v_mov_b32 v28, 0xffff
    v_lshlrev_b64 v[28:29], v26, v[28:29]
    s_mov_b32 s89, 0xffff0000
    s_lshl_b32 s72, s67, 13
    v_or_b32 v15, s72, v15
    s_waitcnt vmcnt(7)
    v_mfma_f32_4x4x4_16b_bf16 v[208:211], v[232:233], v[128:129], 0
    v_mfma_f32_4x4x4_16b_bf16 v[216:219], v[128:129], v[128:129], 0
    v_mfma_f32_4x4x4_16b_bf16 v[212:215], v[232:233], v[130:131], 0
    v_mfma_f32_4x4x4_16b_bf16 v[220:223], v[130:131], v[130:131], 0
    s_waitcnt vmcnt(6)
    v_mfma_f32_4x4x4_16b_bf16 v[208:211], v[232:233], v[132:133], v[208:211]
    v_mfma_f32_4x4x4_16b_bf16 v[216:219], v[132:133], v[132:133], v[216:219]
    v_mfma_f32_4x4x4_16b_bf16 v[212:215], v[232:233], v[134:135], v[212:215]
    v_mfma_f32_4x4x4_16b_bf16 v[220:223], v[134:135], v[134:135], v[220:223]
    s_waitcnt vmcnt(5)
    v_mfma_f32_4x4x4_16b_bf16 v[208:211], v[232:233], v[136:137], v[208:211]
    v_mfma_f32_4x4x4_16b_bf16 v[216:219], v[136:137], v[136:137], v[216:219]
    v_mfma_f32_4x4x4_16b_bf16 v[212:215], v[232:233], v[138:139], v[212:215]
    v_mfma_f32_4x4x4_16b_bf16 v[220:223], v[138:139], v[138:139], v[220:223]
    s_waitcnt vmcnt(4)
    v_mfma_f32_4x4x4_16b_bf16 v[208:211], v[232:233], v[140:141], v[208:211]
    v_mfma_f32_4x4x4_16b_bf16 v[216:219], v[140:141], v[140:141], v[216:219]
    v_mfma_f32_4x4x4_16b_bf16 v[212:215], v[232:233], v[142:143], v[212:215]
    v_mfma_f32_4x4x4_16b_bf16 v[220:223], v[142:143], v[142:143], v[220:223]
    s_waitcnt vmcnt(3)
    v_mfma_f32_4x4x4_16b_bf16 v[208:211], v[232:233], v[144:145], v[208:211]
    v_mfma_f32_4x4x4_16b_bf16 v[216:219], v[144:145], v[144:145], v[216:219]
    v_mfma_f32_4x4x4_16b_bf16 v[212:215], v[232:233], v[146:147], v[212:215]
    v_mfma_f32_4x4x4_16b_bf16 v[220:223], v[146:147], v[146:147], v[220:223]
    s_waitcnt vmcnt(2)
    v_mfma_f32_4x4x4_16b_bf16 v[208:211], v[232:233], v[148:149], v[208:211]
    v_mfma_f32_4x4x4_16b_bf16 v[216:219], v[148:149], v[148:149], v[216:219]
    v_mfma_f32_4x4x4_16b_bf16 v[212:215], v[232:233], v[150:151], v[212:215]
    v_mfma_f32_4x4x4_16b_bf16 v[220:223], v[150:151], v[150:151], v[220:223]
    s_waitcnt vmcnt(1)
    v_mfma_f32_4x4x4_16b_bf16 v[208:211], v[232:233], v[152:153], v[208:211]
    v_mfma_f32_4x4x4_16b_bf16 v[216:219], v[152:153], v[152:153], v[216:219]
    v_mfma_f32_4x4x4_16b_bf16 v[212:215], v[232:233], v[154:155], v[212:215]
    v_mfma_f32_4x4x4_16b_bf16 v[220:223], v[154:155], v[154:155], v[220:223]
    s_waitcnt vmcnt(0)
    s_cmp_eq_u32 s63, 1
    s_cbranch_scc1 L_ln_7
    s_xor_b32 s73, s67, 0
    s_mul_i32 s73, s73, 196608
    s_add_u32 s73, s73, s85
    s_add_u32 m0, s87, 0
    s_add_u32 s72, s73, 0
    buffer_load_dwordx4 v13, s[28:31], s72 offen offset:0 lds
    s_add_u32 m0, s87, 2048
    s_add_u32 s72, s73, 1024
    buffer_load_dwordx4 v13, s[28:31], s72 offen offset:0 lds
    s_add_u32 m0, s87, 4096
    s_add_u32 s72, s73, 2048
    buffer_load_dwordx4 v13, s[28:31], s72 offen offset:0 lds
    s_add_u32 m0, s87, 1024
    s_add_u32 s72, s73, 24576
    buffer_load_dwordx4 v33, s[28:31], s72 offen offset:0 lds
    s_add_u32 m0, s87, 3072
    s_add_u32 s72, s73, 25600
    buffer_load_dwordx4 v33, s[28:31], s72 offen offset:0 lds
    s_add_u32 m0, s87, 5120
    s_add_u32 s72, s73, 26624
    buffer_load_dwordx4 v33, s[28:31], s72 offen offset:0 lds
L_ln_7:
    v_mfma_f32_4x4x4_16b_bf16 v[208:211], v[232:233], v[156:157], v[208:211]
    v_mfma_f32_4x4x4_16b_bf16 v[216:219], v[156:157], v[156:157], v[216:219]
    v_mfma_f32_4x4x4_16b_bf16 v[212:215], v[232:233], v[158:159], v[212:215]
    v_mfma_f32_4x4x4_16b_bf16 v[220:223], v[158:159], v[158:159], v[220:223]
    s_nop 3
    v_add_f32 v24, v208, v212
    v_add_f32 v216, v216, v220
    v_add_f32 v217, v217, v221
    v_add_f32 v218, v218, v222
    v_add_f32 v219, v219, v223
    v_add_f32_dpp v24, v24, v24 quad_perm:[1,0,3,2] row_mask:0xf bank_mask:0xf
    v_mov_b32_dpp v25, v216 quad_perm:[0,0,0,0] row_mask:0xf bank_mask:0xf
    s_nop 1
    v_add_f32_dpp v25, v217, v25 quad_perm:[1,1,1,1] row_mask:0xf bank_mask:0xf
    v_add_f32_dpp v24, v24, v24 quad_perm:[2,3,0,1] row_mask:0xf bank_mask:0xf
    s_nop 0
    v_add_f32_dpp v25, v218, v25 quad_perm:[2,2,2,2] row_mask:0xf bank_mask:0xf
    s_nop 1
    v_add_f32_dpp v25, v219, v25 quad_perm:[3,3,3,3] row_mask:0xf bank_mask:0xf
    v_add_f32_dpp v24, v24, v24 row_half_mirror row_mask:0xf bank_mask:0xf
    s_nop 0
    v_add_f32_dpp v25, v25, v25 row_half_mirror row_mask:0xf bank_mask:0xf
    v_mul_f32 v24, 0x3b000000, v24
    v_mul_f32 v25, 0x3b000000, v25
    v_fma_f32 v25, -v24, v24, v25
    v_max_f32 v25, 0, v25
    v_cvt_pk_bf16_f32 v24, v24, v25
    v_and_b32 v25, s89, v24
    v_add_f32 v25, 0x3727c5ac, v25
    v_cvt_pk_bf16_f32 v25, v25, v25
    v_and_b32 v25, s89, v25
    v_sqrt_f32 v25, v25
    v_lshlrev_b32 v24, 16, v24
    v_cvt_pk_bf16_f32 v25, v25, v25
    v_and_b32 v25, s89, v25
    v_rcp_f32 v26, v25
    s_nop 0
    v_cvt_pk_bf16_f32 v27, v26, v26
    v_and_b32 v25, s89, v27
    v_sub_f32 v25, v26, v25
    v_cvt_pk_bf16_f32 v25, v25, v25
    v_and_b32 v228, v27, v28
    v_and_b32 v229, v27, v29
    v_and_b32 v230, v25, v28
    v_and_b32 v231, v25, v29
    v_mul_f32_e64 v224, -v24, v26
    v_mul_f32_e64 v225, -v24, v26
    v_mul_f32_e64 v226, -v24, v26
    v_mul_f32_e64 v227, -v24, v26
    s_nop 1
    v_mfma_f32_4x4x4_16b_bf16 v[192:195], v[228:229], v[128:129], v[224:227]
    v_mfma_f32_4x4x4_16b_bf16 v[196:199], v[228:229], v[130:131], v[224:227]
    s_nop 0
    v_mfma_f32_4x4x4_16b_bf16 v[192:195], v[230:231], v[128:129], v[192:195]
    v_mfma_f32_4x4x4_16b_bf16 v[196:199], v[230:231], v[130:131], v[196:199]
    v_mfma_f32_4x4x4_16b_bf16 v[200:203], v[228:229], v[132:133], v[224:227]
    s_nop 2
    v_cvt_pk_bf16_f32 v128, v192, v193
    v_mfma_f32_4x4x4_16b_bf16 v[204:207], v[228:229], v[134:135], v[224:227]
    v_cvt_pk_bf16_f32 v129, v194, v195
    v_mfma_f32_4x4x4_16b_bf16 v[200:203], v[230:231], v[132:133], v[200:203]
    v_cvt_pk_bf16_f32 v130, v196, v197
    v_mfma_f32_4x4x4_16b_bf16 v[204:207], v[230:231], v[134:135], v[204:207]
    v_cvt_pk_bf16_f32 v131, v198, v199
    v_xor_b32 v23, 0x0, v15
    ds_write_b128 v23, v[128:131]
    v_mfma_f32_4x4x4_16b_bf16 v[192:195], v[228:229], v[136:137], v[224:227]
    v_cvt_pk_bf16_f32 v132, v200, v201
    v_mfma_f32_4x4x4_16b_bf16 v[196:199], v[228:229], v[138:139], v[224:227]
    v_cvt_pk_bf16_f32 v133, v202, v203
    v_mfma_f32_4x4x4_16b_bf16 v[192:195], v[230:231], v[136:137], v[192:195]
    v_cvt_pk_bf16_f32 v134, v204, v205
    v_mfma_f32_4x4x4_16b_bf16 v[196:199], v[230:231], v[138:139], v[196:199]
    v_cvt_pk_bf16_f32 v135, v206, v207
    v_xor_b32 v23, 0x2000, v15
    ds_write_b128 v23, v[132:135]
    v_mfma_f32_4x4x4_16b_bf16 v[200:203], v[228:229], v[140:141], v[224:227]
    v_cvt_pk_bf16_f32 v136, v192, v193
    v_mfma_f32_4x4x4_16b_bf16 v[204:207], v[228:229], v[142:143], v[224:227]
    v_cvt_pk_bf16_f32 v137, v194, v195
    v_mfma_f32_4x4x4_16b_bf16 v[200:203], v[230:231], v[140:141], v[200:203]
    v_cvt_pk_bf16_f32 v138, v196, v197
    v_mfma_f32_4x4x4_16b_bf16 v[204:207], v[230:231], v[142:143], v[204:207]
    v_cvt_pk_bf16_f32 v139, v198, v199
    v_xor_b32 v23, 0x4000, v15
    ds_write_b128 v23, v[136:139]
    v_mfma_f32_4x4x4_16b_bf16 v[192:195], v[228:229], v[144:145], v[224:227]
    v_cvt_pk_bf16_f32 v140, v200, v201
    v_mfma_f32_4x4x4_16b_bf16 v[196:199], v[228:229], v[146:147], v[224:227]
    v_cvt_pk_bf16_f32 v141, v202, v203
    v_mfma_f32_4x4x4_16b_bf16 v[192:195], v[230:231], v[144:145], v[192:195]
    v_cvt_pk_bf16_f32 v142, v204, v205
    v_mfma_f32_4x4x4_16b_bf16 v[196:199], v[230:231], v[146:147], v[196:199]
    v_cvt_pk_bf16_f32 v143, v206, v207
    v_xor_b32 v23, 0x6000, v15
    ds_write_b128 v23, v[140:143]
    v_mfma_f32_4x4x4_16b_bf16 v[200:203], v[228:229], v[148:149], v[224:227]
    v_cvt_pk_bf16_f32 v144, v192, v193
    v_mfma_f32_4x4x4_16b_bf16 v[204:207], v[228:229], v[150:151], v[224:227]
    v_cvt_pk_bf16_f32 v145, v194, v195
    v_mfma_f32_4x4x4_16b_bf16 v[200:203], v[230:231], v[148:149], v[200:203]
    v_cvt_pk_bf16_f32 v146, v196, v197
    v_mfma_f32_4x4x4_16b_bf16 v[204:207], v[230:231], v[150:151], v[204:207]
    v_cvt_pk_bf16_f32 v147, v198, v199
    v_xor_b32 v23, 0x8000, v15
    ds_write_b128 v23, v[144:147]
    v_mfma_f32_4x4x4_16b_bf16 v[192:195], v[228:229], v[152:153], v[224:227]
    v_cvt_pk_bf16_f32 v148, v200, v201
    v_mfma_f32_4x4x4_16b_bf16 v[196:199], v[228:229], v[154:155], v[224:227]
    v_cvt_pk_bf16_f32 v149, v202, v203
    v_mfma_f32_4x4x4_16b_bf16 v[192:195], v[230:231], v[152:153], v[192:195]
    v_cvt_pk_bf16_f32 v150, v204, v205
    v_mfma_f32_4x4x4_16b_bf16 v[196:199], v[230:231], v[154:155], v[196:199]
    v_cvt_pk_bf16_f32 v151, v206, v207
    v_xor_b32 v23, 0xa000, v15
    ds_write_b128 v23, v[148:151]
    v_mfma_f32_4x4x4_16b_bf16 v[200:203], v[228:229], v[156:157], v[224:227]
    v_cvt_pk_bf16_f32 v152, v192, v193
    v_mfma_f32_4x4x4_16b_bf16 v[204:207], v[228:229], v[158:159], v[224:227]
    v_cvt_pk_bf16_f32 v153, v194, v195
    v_mfma_f32_4x4x4_16b_bf16 v[200:203], v[230:231], v[156:157], v[200:203]
    v_cvt_pk_bf16_f32 v154, v196, v197
    v_mfma_f32_4x4x4_16b_bf16 v[204:207], v[230:231], v[158:159], v[204:207]
    v_cvt_pk_bf16_f32 v155, v198, v199
    v_xor_b32 v23, 0xc000, v15
    ds_write_b128 v23, v[152:155]
    v_cvt_pk_bf16_f32 v156, v200, v201
    v_cvt_pk_bf16_f32 v157, v202, v203
    v_cvt_pk_bf16_f32 v158, v204, v205
    v_cvt_pk_bf16_f32 v159, v206, v207
    v_xor_b32 v23, 0xe000, v15
    ds_write_b128 v23, v[156:159]
    s_cmp_eq_u32 s63, 1
    s_cbranch_scc1 L_ln_10
    s_lshr_b32 s3, s60, 1
    s_add_u32 s3, s3, s69
    s_lshl_b32 s3, s3, 6
    buffer_load_dwordx2 v[112:113], v10, s[40:43], s3 offen offset:0
    buffer_load_dwordx2 v[114:115], v10, s[40:43], s3 offen offset:16
    buffer_load_dwordx2 v[116:117], v10, s[40:43], s3 offen offset:128
    buffer_load_dwordx2 v[118:119], v10, s[40:43], s3 offen offset:144
    buffer_load_dwordx2 v[120:121], v10, s[40:43], s3 offen offset:256
    buffer_load_dwordx2 v[122:123], v10, s[40:43], s3 offen offset:272
    s_xor_b32 s73, s67, 1
    s_mul_i32 s73, s73, 196608
    s_add_u32 s73, s73, s85
    s_add_u32 m0, s87, 24576
    s_add_u32 s72, s73, 0
    buffer_load_dwordx4 v13, s[28:31], s72 offen offset:0 lds
    s_add_u32 m0, s87, 26624
    s_add_u32 s72, s73, 1024
    buffer_load_dwordx4 v13, s[28:31], s72 offen offset:0 lds
    s_add_u32 m0, s87, 28672
    s_add_u32 s72, s73, 2048
    buffer_load_dwordx4 v13, s[28:31], s72 offen offset:0 lds
    s_add_u32 m0, s87, 25600
    s_add_u32 s72, s73, 24576
    buffer_load_dwordx4 v33, s[28:31], s72 offen offset:0 lds
    s_add_u32 m0, s87, 27648
    s_add_u32 s72, s73, 25600
    buffer_load_dwordx4 v33, s[28:31], s72 offen offset:0 lds
    s_add_u32 m0, s87, 29696
    s_add_u32 s72, s73, 26624
    buffer_load_dwordx4 v33, s[28:31], s72 offen offset:0 lds
L_ln_10:
    s_cmp_eq_u32 s63, 1
    s_cbranch_scc1 L_loader
    s_waitcnt vmcnt(12)
    s_waitcnt lgkmcnt(0)
    s_add_u32 s68, s68, 0x9e3779b9
    s_barrier
    ds_read_b128 v[128:131], v16 offset:0
    ds_read_b64_tr_b16 v[72:73], v8 offset:0
    ds_read_b128 v[132:135], v16 offset:2048
    ds_read_b64_tr_b16 v[74:75], v8 offset:512
    ds_read_b64_tr_b16 v[76:77], v18 offset:0
    ds_read_b64_tr_b16 v[78:79], v18 offset:512
    ds_read_b64_tr_b16 v[80:81], v8 offset:2048
    ds_read_b64_tr_b16 v[82:83], v8 offset:2560
    ds_read_b64_tr_b16 v[84:85], v18 offset:2048
    ds_read_b64_tr_b16 v[86:87], v18 offset:2560
    ds_read_b64_tr_b16 v[88:89], v8 offset:4096
    ds_read_b64_tr_b16 v[90:91], v8 offset:4608
    s_waitcnt lgkmcnt(8)
    v_mfma_f32_16x16x32_bf16 v[32:35], v[72:75], v[132:135], 0
    ds_read_b64_tr_b16 v[92:93], v18 offset:4096
    s_and_b32 s74, s60, 1
    v_mfma_f32_16x16x32_bf16 v[24:27], v[72:75], v[128:131], 0
    ds_read_b64_tr_b16 v[94:95], v18 offset:4608
    s_waitcnt lgkmcnt(8)
    v_mfma_f32_16x16x32_bf16 v[36:39], v[76:79], v[132:135], 0
    ds_read_b128 v[136:139], v17 offset:0
    ds_read_b64_tr_b16 v[72:73], v8 offset:12288
    s_lshr_b32 s75, s60, 1
    v_mfma_f32_16x16x32_bf16 v[28:31], v[76:79], v[128:131], 0
    ds_read_b128 v[140:143], v17 offset:2048
    ds_read_b64_tr_b16 v[74:75], v8 offset:12800
    s_waitcnt lgkmcnt(10)
    v_mfma_f32_16x16x32_bf16 v[48:51], v[80:83], v[132:135], 0
    ds_read_b64_tr_b16 v[76:77], v18 offset:12288
    s_lshl1_add_u32 s72, s64, s74
    v_mfma_f32_16x16x32_bf16 v[40:43], v[80:83], v[128:131], 0
    ds_read_b64_tr_b16 v[78:79], v18 offset:12800
    s_waitcnt lgkmcnt(10)
    v_mfma_f32_16x16x32_bf16 v[52:55], v[84:87], v[132:135], 0
    ds_read_b64_tr_b16 v[80:81], v8 offset:14336
    s_lshl_b32 s83, s72, 17
    v_mfma_f32_16x16x32_bf16 v[44:47], v[84:87], v[128:131], 0
    ds_read_b64_tr_b16 v[82:83], v8 offset:14848
    s_waitcnt lgkmcnt(10)
    v_mfma_f32_16x16x32_bf16 v[60:63], v[132:135], v[88:91], 0
    ds_read_b64_tr_b16 v[84:85], v18 offset:14336
    s_add_u32 s83, s83, 3145728
    v_mfma_f32_16x16x32_bf16 v[56:59], v[128:131], v[88:91], 0
    ds_read_b64_tr_b16 v[86:87], v18 offset:14848
    s_waitcnt lgkmcnt(10)
    v_mfma_f32_16x16x32_bf16 v[68:71], v[132:135], v[92:95], 0
    ds_read_b64_tr_b16 v[88:89], v8 offset:16384
    s_and_b32 s73, s75, 1
    v_mfma_f32_16x16x32_bf16 v[64:67], v[128:131], v[92:95], 0
    ds_read_b64_tr_b16 v[90:91], v8 offset:16896
    s_waitcnt lgkmcnt(8)
    v_mfma_f32_16x16x32_bf16 v[32:35], v[72:75], v[140:143], v[32:35]
    ds_read_b64_tr_b16 v[92:93], v18 offset:16384
    s_lshl_b32 s73, s73, 16
    v_mfma_f32_16x16x32_bf16 v[24:27], v[72:75], v[136:139], v[24:27]
    ds_read_b64_tr_b16 v[94:95], v18 offset:16896
    s_waitcnt lgkmcnt(8)
    v_mfma_f32_16x16x32_bf16 v[36:39], v[76:79], v[140:143], v[36:39]
    s_waitcnt vmcnt(0)
    s_barrier
    ds_read_b128 v[144:147], v16 offset:8192
    ds_read_b64_tr_b16 v[72:73], v8 offset:24576
    s_add_u32 s82, s83, s73
    v_mfma_f32_16x16x32_bf16 v[28:31], v[76:79], v[136:139], v[28:31]
    ds_read_b128 v[148:151], v16 offset:10240
    ds_read_b64_tr_b16 v[74:75], v8 offset:25088
    s_waitcnt lgkmcnt(10)
    v_mfma_f32_16x16x32_bf16 v[48:51], v[80:83], v[140:143], v[48:51]
    ds_read_b64_tr_b16 v[76:77], v18 offset:24576
    s_lshl_b32 s72, s65, 6
    v_mfma_f32_16x16x32_bf16 v[40:43], v[80:83], v[136:139], v[40:43]
    ds_read_b64_tr_b16 v[78:79], v18 offset:25088
    s_waitcnt lgkmcnt(10)
    v_mfma_f32_16x16x32_bf16 v[52:55], v[84:87], v[140:143], v[52:55]
    ds_read_b64_tr_b16 v[80:81], v8 offset:26624
    s_add_u32 s72, s72, s64
    v_mfma_f32_16x16x32_bf16 v[44:47], v[84:87], v[136:139], v[44:47]
    ds_read_b64_tr_b16 v[82:83], v8 offset:27136
    s_waitcnt lgkmcnt(10)
    v_mfma_f32_16x16x32_bf16 v[60:63], v[140:143], v[88:91], v[60:63]
    ds_read_b64_tr_b16 v[84:85], v18 offset:26624
    s_lshl1_add_u32 s72, s72, s74
    v_mfma_f32_16x16x32_bf16 v[56:59], v[136:139], v[88:91], v[56:59]
    ds_read_b64_tr_b16 v[86:87], v18 offset:27136
    s_waitcnt lgkmcnt(10)
    v_mfma_f32_16x16x32_bf16 v[68:71], v[140:143], v[92:95], v[68:71]
    ds_read_b64_tr_b16 v[88:89], v8 offset:28672
    s_lshl_b32 s72, s72, 10
    v_mfma_f32_16x16x32_bf16 v[64:67], v[136:139], v[92:95], v[64:67]
    ds_read_b64_tr_b16 v[90:91], v8 offset:29184
    s_waitcnt lgkmcnt(8)
    v_mfma_f32_16x16x32_bf16 v[32:35], v[72:75], v[148:151], v[32:35]
    ds_read_b64_tr_b16 v[92:93], v18 offset:28672
    s_add_u32 s72, s72, 1048576
    v_mfma_f32_16x16x32_bf16 v[24:27], v[72:75], v[144:147], v[24:27]
    ds_read_b64_tr_b16 v[94:95], v18 offset:29184
    s_waitcnt lgkmcnt(8)
    v_mfma_f32_16x16x32_bf16 v[36:39], v[76:79], v[148:151], v[36:39]
    ds_read_b128 v[152:155], v17 offset:8192
    ds_read_b64_tr_b16 v[72:73], v8 offset:36864
    s_mul_i32 s84, s74, 27648
    v_mfma_f32_16x16x32_bf16 v[28:31], v[76:79], v[144:147], v[28:31]
    ds_read_b128 v[156:159], v17 offset:10240
    ds_read_b64_tr_b16 v[74:75], v8 offset:37376
    s_waitcnt lgkmcnt(10)
    v_mfma_f32_16x16x32_bf16 v[48:51], v[80:83], v[148:151], v[48:51]
    ds_read_b64_tr_b16 v[76:77], v18 offset:36864
    s_add_u32 s84, s84, 65536
    v_mfma_f32_16x16x32_bf16 v[40:43], v[80:83], v[144:147], v[40:43]
    ds_read_b64_tr_b16 v[78:79], v18 offset:37376
    s_waitcnt lgkmcnt(10)
    v_mfma_f32_16x16x32_bf16 v[52:55], v[84:87], v[148:151], v[52:55]
    ds_read_b64_tr_b16 v[80:81], v8 offset:38912
    s_xor_b32 s73, s75, 3
    v_mfma_f32_16x16x32_bf16 v[44:47], v[84:87], v[144:147], v[44:47]
    ds_read_b64_tr_b16 v[82:83], v8 offset:39424
    s_waitcnt lgkmcnt(10)
    v_mfma_f32_16x16x32_bf16 v[60:63], v[148:151], v[88:91], v[60:63]
    ds_read_b64_tr_b16 v[84:85], v18 offset:38912
    s_mul_i32 s96, s73, 6912
    v_mfma_f32_16x16x32_bf16 v[56:59], v[144:147], v[88:91], v[56:59]
    ds_read_b64_tr_b16 v[86:87], v18 offset:39424
    s_waitcnt lgkmcnt(10)
    v_mfma_f32_16x16x32_bf16 v[68:71], v[148:151], v[92:95], v[68:71]
    ds_read_b64_tr_b16 v[88:89], v8 offset:40960
    s_lshl_b32 s73, s73, 15
    v_mfma_f32_16x16x32_bf16 v[64:67], v[144:147], v[92:95], v[64:67]
    ds_read_b64_tr_b16 v[90:91], v8 offset:41472
    s_waitcnt lgkmcnt(8)
    v_mfma_f32_16x16x32_bf16 v[32:35], v[72:75], v[156:159], v[32:35]
    ds_read_b64_tr_b16 v[92:93], v18 offset:40960
    s_add_u32 s92, s72, s73
    v_mfma_f32_16x16x32_bf16 v[24:27], v[72:75], v[152:155], v[24:27]
    ds_read_b64_tr_b16 v[94:95], v18 offset:41472
    s_waitcnt lgkmcnt(8)
    v_mfma_f32_16x16x32_bf16 v[36:39], v[76:79], v[156:159], v[36:39]
    s_barrier
    ds_read_b128 v[160:163], v16 offset:16384
    ds_read_b64_tr_b16 v[72:73], v9 offset:0
    s_add_u32 s96, s96, s84
    v_mfma_f32_16x16x32_bf16 v[28:31], v[76:79], v[152:155], v[28:31]
    ds_read_b128 v[164:167], v16 offset:18432
    ds_read_b64_tr_b16 v[74:75], v9 offset:512
    s_waitcnt lgkmcnt(10)
    v_mfma_f32_16x16x32_bf16 v[48:51], v[80:83], v[156:159], v[48:51]
    ds_read_b64_tr_b16 v[76:77], v19 offset:0
    s_xor_b32 s73, s75, 2
    v_mfma_f32_16x16x32_bf16 v[40:43], v[80:83], v[152:155], v[40:43]
    ds_read_b64_tr_b16 v[78:79], v19 offset:512
    s_waitcnt lgkmcnt(10)
    v_mfma_f32_16x16x32_bf16 v[52:55], v[84:87], v[156:159], v[52:55]
    ds_read_b64_tr_b16 v[80:81], v9 offset:2048
    s_mul_i32 s97, s73, 6912
    v_mfma_f32_16x16x32_bf16 v[44:47], v[84:87], v[152:155], v[44:47]
    ds_read_b64_tr_b16 v[82:83], v9 offset:2560
    s_waitcnt lgkmcnt(10)
    v_mfma_f32_16x16x32_bf16 v[60:63], v[156:159], v[88:91], v[60:63]
    ds_read_b64_tr_b16 v[84:85], v19 offset:2048
    s_lshl_b32 s73, s73, 15
    v_mfma_f32_16x16x32_bf16 v[56:59], v[152:155], v[88:91], v[56:59]
    ds_read_b64_tr_b16 v[86:87], v19 offset:2560
    s_waitcnt lgkmcnt(10)
    v_mfma_f32_16x16x32_bf16 v[68:71], v[156:159], v[92:95], v[68:71]
    ds_read_b64_tr_b16 v[88:89], v9 offset:4096
    s_add_u32 s93, s72, s73
    v_mfma_f32_16x16x32_bf16 v[64:67], v[152:155], v[92:95], v[64:67]
    ds_read_b64_tr_b16 v[90:91], v9 offset:4608
    s_waitcnt lgkmcnt(8)
    v_mfma_f32_16x16x32_bf16 v[32:35], v[72:75], v[164:167], v[32:35]
    ds_read_b64_tr_b16 v[92:93], v19 offset:4096
    s_add_u32 s97, s97, s84
    v_mfma_f32_16x16x32_bf16 v[24:27], v[72:75], v[160:163], v[24:27]
    ds_read_b64_tr_b16 v[94:95], v19 offset:4608
    s_waitcnt lgkmcnt(8)
    v_mfma_f32_16x16x32_bf16 v[36:39], v[76:79], v[164:167], v[36:39]
    ds_read_b128 v[168:171], v17 offset:16384
    ds_read_b64_tr_b16 v[72:73], v9 offset:12288
    s_xor_b32 s73, s75, 1
    v_mfma_f32_16x16x32_bf16 v[28:31], v[76:79], v[160:163], v[28:31]
    ds_read_b128 v[172:175], v17 offset:18432
    ds_read_b64_tr_b16 v[74:75], v9 offset:12800
    s_waitcnt lgkmcnt(10)
    v_mfma_f32_16x16x32_bf16 v[48:51], v[80:83], v[164:167], v[48:51]
    ds_read_b64_tr_b16 v[76:77], v19 offset:12288
    s_mul_i32 s98, s73, 6912
    v_mfma_f32_16x16x32_bf16 v[40:43], v[80:83], v[160:163], v[40:43]
    ds_read_b64_tr_b16 v[78:79], v19 offset:12800
    s_waitcnt lgkmcnt(10)
    v_mfma_f32_16x16x32_bf16 v[52:55], v[84:87], v[164:167], v[52:55]
    ds_read_b64_tr_b16 v[80:81], v9 offset:14336
    s_lshl_b32 s73, s73, 15
    v_mfma_f32_16x16x32_bf16 v[44:47], v[84:87], v[160:163], v[44:47]
    ds_read_b64_tr_b16 v[82:83], v9 offset:14848
    s_waitcnt lgkmcnt(10)
    v_mfma_f32_16x16x32_bf16 v[60:63], v[164:167], v[88:91], v[60:63]
    ds_read_b64_tr_b16 v[84:85], v19 offset:14336
    s_add_u32 s94, s72, s73
    v_mfma_f32_16x16x32_bf16 v[56:59], v[160:163], v[88:91], v[56:59]
    ds_read_b64_tr_b16 v[86:87], v19 offset:14848
    s_waitcnt lgkmcnt(10)
    v_mfma_f32_16x16x32_bf16 v[68:71], v[164:167], v[92:95], v[68:71]
    ds_read_b64_tr_b16 v[88:89], v9 offset:16384
    s_add_u32 s98, s98, s84
    v_mfma_f32_16x16x32_bf16 v[64:67], v[160:163], v[92:95], v[64:67]
    ds_read_b64_tr_b16 v[90:91], v9 offset:16896
    s_waitcnt lgkmcnt(8)
    v_mfma_f32_16x16x32_bf16 v[32:35], v[72:75], v[172:175], v[32:35]
    ds_read_b64_tr_b16 v[92:93], v19 offset:16384
    s_xor_b32 s73, s75, 0
    v_mfma_f32_16x16x32_bf16 v[24:27], v[72:75], v[168:171], v[24:27]
    ds_read_b64_tr_b16 v[94:95], v19 offset:16896
    s_waitcnt lgkmcnt(8)
    v_mfma_f32_16x16x32_bf16 v[36:39], v[76:79], v[172:175], v[36:39]
    s_barrier
    ds_read_b128 v[176:179], v16 offset:24576
    ds_read_b64_tr_b16 v[72:73], v9 offset:24576
    s_mul_i32 s99, s73, 6912
    v_mfma_f32_16x16x32_bf16 v[28:31], v[76:79], v[168:171], v[28:31]
    ds_read_b128 v[180:183], v16 offset:26624
    ds_read_b64_tr_b16 v[74:75], v9 offset:25088
    s_waitcnt lgkmcnt(10)
    v_mfma_f32_16x16x32_bf16 v[48:51], v[80:83], v[172:175], v[48:51]
    ds_read_b64_tr_b16 v[76:77], v19 offset:24576
    s_lshl_b32 s73, s73, 15
    v_mfma_f32_16x16x32_bf16 v[40:43], v[80:83], v[168:171], v[40:43]
    ds_read_b64_tr_b16 v[78:79], v19 offset:25088
    s_waitcnt lgkmcnt(10)
    v_mfma_f32_16x16x32_bf16 v[52:55], v[84:87], v[172:175], v[52:55]
    ds_read_b64_tr_b16 v[80:81], v9 offset:26624
    s_add_u32 s95, s72, s73
    v_mfma_f32_16x16x32_bf16 v[44:47], v[84:87], v[168:171], v[44:47]
    ds_read_b64_tr_b16 v[82:83], v9 offset:27136
    s_waitcnt lgkmcnt(10)
    v_mfma_f32_16x16x32_bf16 v[60:63], v[172:175], v[88:91], v[60:63]
    ds_read_b64_tr_b16 v[84:85], v19 offset:26624
    s_add_u32 s99, s99, s84
    v_mfma_f32_16x16x32_bf16 v[56:59], v[168:171], v[88:91], v[56:59]
    ds_read_b64_tr_b16 v[86:87], v19 offset:27136
    s_waitcnt lgkmcnt(10)
    v_mfma_f32_16x16x32_bf16 v[68:71], v[172:175], v[92:95], v[68:71]
    ds_read_b64_tr_b16 v[88:89], v9 offset:28672
    s_add_u32 s82, s82, 22528
    v_mfma_f32_16x16x32_bf16 v[64:67], v[168:171], v[92:95], v[64:67]
    ds_read_b64_tr_b16 v[90:91], v9 offset:29184
    s_waitcnt lgkmcnt(8)
    v_mfma_f32_16x16x32_bf16 v[32:35], v[72:75], v[180:183], v[32:35]
    ds_read_b64_tr_b16 v[92:93], v19 offset:28672
    s_mul_i32 s84, s60, 10240
    v_mfma_f32_16x16x32_bf16 v[24:27], v[72:75], v[176:179], v[24:27]
    ds_read_b64_tr_b16 v[94:95], v19 offset:29184
    s_waitcnt lgkmcnt(8)
    v_mfma_f32_16x16x32_bf16 v[36:39], v[76:79], v[180:183], v[36:39]
    ds_read_b128 v[184:187], v17 offset:24576
    ds_read_b64_tr_b16 v[72:73], v9 offset:36864
    s_add_u32 s84, s84, 120832
    v_mfma_f32_16x16x32_bf16 v[28:31], v[76:79], v[176:179], v[28:31]
    ds_read_b128 v[188:191], v17 offset:26624
    ds_read_b64_tr_b16 v[74:75], v9 offset:37376
    s_waitcnt lgkmcnt(10)
    v_mfma_f32_16x16x32_bf16 v[48:51], v[80:83], v[180:183], v[48:51]
    ds_read_b64_tr_b16 v[76:77], v19 offset:36864
    s_lshl1_add_u32 s72, s62, s74
    v_mfma_f32_16x16x32_bf16 v[40:43], v[80:83], v[176:179], v[40:43]
    ds_read_b64_tr_b16 v[78:79], v19 offset:37376
    s_waitcnt lgkmcnt(10)
    v_mfma_f32_16x16x32_bf16 v[52:55], v[84:87], v[180:183], v[52:55]
    ds_read_b64_tr_b16 v[80:81], v9 offset:38912
    s_lshl1_add_u32 s73, s61, s75
    v_mfma_f32_16x16x32_bf16 v[44:47], v[84:87], v[176:179], v[44:47]
    ds_read_b64_tr_b16 v[82:83], v9 offset:39424
    s_waitcnt lgkmcnt(10)
    v_mfma_f32_16x16x32_bf16 v[60:63], v[180:183], v[88:91], v[60:63]
    ds_read_b64_tr_b16 v[84:85], v19 offset:38912
    s_lshl_b32 s76, s73, 7
    v_mfma_f32_16x16x32_bf16 v[56:59], v[176:179], v[88:91], v[56:59]
    ds_read_b64_tr_b16 v[86:87], v19 offset:39424
    s_waitcnt lgkmcnt(10)
    v_mfma_f32_16x16x32_bf16 v[68:71], v[180:183], v[92:95], v[68:71]
    ds_read_b64_tr_b16 v[88:89], v9 offset:40960
    s_add_u32 s76, s76, s72
    v_mfma_f32_16x16x32_bf16 v[64:67], v[176:179], v[92:95], v[64:67]
    ds_read_b64_tr_b16 v[90:91], v9 offset:41472
    s_waitcnt lgkmcnt(8)
    v_mfma_f32_16x16x32_bf16 v[32:35], v[72:75], v[188:191], v[32:35]
    ds_read_b64_tr_b16 v[92:93], v19 offset:40960
    s_lshl_b32 s77, s76, 11
    v_mfma_f32_16x16x32_bf16 v[24:27], v[72:75], v[184:187], v[24:27]
    ds_read_b64_tr_b16 v[94:95], v19 offset:41472
    s_waitcnt lgkmcnt(8)
    v_mfma_f32_16x16x32_bf16 v[36:39], v[76:79], v[188:191], v[36:39]
    s_barrier
    ds_read_b128 v[192:195], v16 offset:32768
    ds_read_b64_tr_b16 v[72:73], v8 offset:0
    s_lshl4_add_u32 s76, s72, s73
    v_mfma_f32_16x16x32_bf16 v[28:31], v[76:79], v[184:187], v[28:31]
    ds_read_b128 v[196:199], v16 offset:34816
    ds_read_b64_tr_b16 v[74:75], v8 offset:512
    s_waitcnt lgkmcnt(10)
    v_mfma_f32_16x16x32_bf16 v[48:51], v[80:83], v[188:191], v[48:51]
    ds_read_b64_tr_b16 v[76:77], v18 offset:0
    s_lshl_b32 s76, s76, 11
    v_mfma_f32_16x16x32_bf16 v[40:43], v[80:83], v[184:187], v[40:43]
    ds_read_b64_tr_b16 v[78:79], v18 offset:512
    s_waitcnt lgkmcnt(10)
    v_mfma_f32_16x16x32_bf16 v[52:55], v[84:87], v[188:191], v[52:55]
    ds_read_b64_tr_b16 v[80:81], v8 offset:2048
    s_add_u32 s76, s76, 1048576
    v_mfma_f32_16x16x32_bf16 v[44:47], v[84:87], v[184:187], v[44:47]
    ds_read_b64_tr_b16 v[82:83], v8 offset:2560
    s_waitcnt lgkmcnt(10)
    v_mfma_f32_16x16x32_bf16 v[60:63], v[188:191], v[88:91], v[60:63]
    ds_read_b64_tr_b16 v[84:85], v18 offset:2048
    s_add_u32 s77, s77, 3145728
    v_mfma_f32_16x16x32_bf16 v[56:59], v[184:187], v[88:91], v[56:59]
    ds_read_b64_tr_b16 v[86:87], v18 offset:2560
    s_waitcnt lgkmcnt(10)
    v_mfma_f32_16x16x32_bf16 v[68:71], v[188:191], v[92:95], v[68:71]
    ds_read_b64_tr_b16 v[88:89], v8 offset:4096
    s_add_u32 s81, s69, s75
    v_mfma_f32_16x16x32_bf16 v[64:67], v[184:187], v[92:95], v[64:67]
    ds_read_b64_tr_b16 v[90:91], v8 offset:4608
    s_waitcnt lgkmcnt(8)
    v_mfma_f32_16x16x32_bf16 v[32:35], v[72:75], v[196:199], v[32:35]
    ds_read_b64_tr_b16 v[92:93], v18 offset:4096
    s_lshl_b32 s78, s81, 7
    v_mfma_f32_16x16x32_bf16 v[24:27], v[72:75], v[192:195], v[24:27]
    ds_read_b64_tr_b16 v[94:95], v18 offset:4608
    s_waitcnt lgkmcnt(8)
    v_mfma_f32_16x16x32_bf16 v[36:39], v[76:79], v[196:199], v[36:39]
    ds_read_b128 v[200:203], v17 offset:32768
    ds_read_b64_tr_b16 v[72:73], v8 offset:12288
    s_add_u32 s78, s78, s72
    v_mfma_f32_16x16x32_bf16 v[28:31], v[76:79], v[192:195], v[28:31]
    ds_read_b128 v[204:207], v17 offset:34816
    ds_read_b64_tr_b16 v[74:75], v8 offset:12800
    s_waitcnt lgkmcnt(10)
    v_mfma_f32_16x16x32_bf16 v[48:51], v[80:83], v[196:199], v[48:51]
    ds_read_b64_tr_b16 v[76:77], v18 offset:12288
    s_lshl_b32 s78, s78, 10
    v_mfma_f32_16x16x32_bf16 v[40:43], v[80:83], v[192:195], v[40:43]
    ds_read_b64_tr_b16 v[78:79], v18 offset:12800
    s_waitcnt lgkmcnt(10)
    v_mfma_f32_16x16x32_bf16 v[52:55], v[84:87], v[196:199], v[52:55]
    ds_read_b64_tr_b16 v[80:81], v8 offset:14336
    s_add_u32 s78, s78, 7340032
    v_mfma_f32_16x16x32_bf16 v[44:47], v[84:87], v[192:195], v[44:47]
    ds_read_b64_tr_b16 v[82:83], v8 offset:14848
    s_waitcnt lgkmcnt(10)
    v_mfma_f32_16x16x32_bf16 v[60:63], v[196:199], v[88:91], v[60:63]
    ds_read_b64_tr_b16 v[84:85], v18 offset:14336
    s_lshl_b32 s79, s61, 6
    v_mfma_f32_16x16x32_bf16 v[56:59], v[192:195], v[88:91], v[56:59]
    ds_read_b64_tr_b16 v[86:87], v18 offset:14848
    s_waitcnt lgkmcnt(10)
    v_mfma_f32_16x16x32_bf16 v[68:71], v[196:199], v[92:95], v[68:71]
    ds_read_b64_tr_b16 v[88:89], v8 offset:16384
    s_add_u32 s79, s79, s62
    v_mfma_f32_16x16x32_bf16 v[64:67], v[192:195], v[92:95], v[64:67]
    ds_read_b64_tr_b16 v[90:91], v8 offset:16896
    s_waitcnt lgkmcnt(8)
    v_mfma_f32_16x16x32_bf16 v[32:35], v[72:75], v[204:207], v[32:35]
    ds_read_b64_tr_b16 v[92:93], v18 offset:16384
    s_lshl_b32 s79, s79, 4
    v_mfma_f32_16x16x32_bf16 v[24:27], v[72:75], v[200:203], v[24:27]
    ds_read_b64_tr_b16 v[94:95], v18 offset:16896
    s_waitcnt lgkmcnt(8)
    v_mfma_f32_16x16x32_bf16 v[36:39], v[76:79], v[204:207], v[36:39]
    s_barrier
    ds_read_b128 v[208:211], v16 offset:40960
    ds_read_b64_tr_b16 v[72:73], v8 offset:24576
    s_add_u32 s79, s79, 4608
    v_mfma_f32_16x16x32_bf16 v[28:31], v[76:79], v[200:203], v[28:31]
    ds_read_b128 v[212:215], v16 offset:43008
    ds_read_b64_tr_b16 v[74:75], v8 offset:25088
    s_waitcnt lgkmcnt(10)
    v_mfma_f32_16x16x32_bf16 v[48:51], v[80:83], v[204:207], v[48:51]
    ds_read_b64_tr_b16 v[76:77], v18 offset:24576
    s_lshl_b32 s80, s62, 3
    v_mfma_f32_16x16x32_bf16 v[40:43], v[80:83], v[200:203], v[40:43]
    ds_read_b64_tr_b16 v[78:79], v18 offset:25088
    s_waitcnt lgkmcnt(10)
    v_mfma_f32_16x16x32_bf16 v[52:55], v[84:87], v[204:207], v[52:55]
    ds_read_b64_tr_b16 v[80:81], v8 offset:26624
    s_add_u32 s80, s80, s61
    v_mfma_f32_16x16x32_bf16 v[44:47], v[84:87], v[200:203], v[44:47]
    ds_read_b64_tr_b16 v[82:83], v8 offset:27136
    s_waitcnt lgkmcnt(10)
    v_mfma_f32_16x16x32_bf16 v[60:63], v[204:207], v[88:91], v[60:63]
    ds_read_b64_tr_b16 v[84:85], v18 offset:26624
    s_lshl2_add_u32 s80, s80, s60
    v_mfma_f32_16x16x32_bf16 v[56:59], v[200:203], v[88:91], v[56:59]
    ds_read_b64_tr_b16 v[86:87], v18 offset:27136
    s_waitcnt lgkmcnt(10)
    v_mfma_f32_16x16x32_bf16 v[68:71], v[204:207], v[92:95], v[68:71]
    ds_read_b64_tr_b16 v[88:89], v8 offset:28672
    s_lshl_b32 s80, s80, 4
    v_mfma_f32_16x16x32_bf16 v[64:67], v[200:203], v[92:95], v[64:67]
    ds_read_b64_tr_b16 v[90:91], v8 offset:29184
    s_waitcnt lgkmcnt(8)
    v_mfma_f32_16x16x32_bf16 v[32:35], v[72:75], v[212:215], v[32:35]
    ds_read_b64_tr_b16 v[92:93], v18 offset:28672
    s_add_u32 s80, s80, 393216
    v_mfma_f32_16x16x32_bf16 v[24:27], v[72:75], v[208:211], v[24:27]
    ds_read_b64_tr_b16 v[94:95], v18 offset:29184
    s_waitcnt lgkmcnt(8)
    v_mfma_f32_16x16x32_bf16 v[36:39], v[76:79], v[212:215], v[36:39]
    ds_read_b128 v[216:219], v17 offset:40960
    ds_read_b64_tr_b16 v[72:73], v8 offset:36864
    s_mul_i32 s73, s61, s75
    v_mfma_f32_16x16x32_bf16 v[28:31], v[76:79], v[208:211], v[28:31]
    ds_read_b128 v[220:223], v17 offset:43008
    ds_read_b64_tr_b16 v[74:75], v8 offset:37376
    s_waitcnt lgkmcnt(10)
    v_mfma_f32_16x16x32_bf16 v[48:51], v[80:83], v[212:215], v[48:51]
    ds_read_b64_tr_b16 v[76:77], v18 offset:36864
    s_add_u32 s88, s78, 524288
    v_mfma_f32_16x16x32_bf16 v[40:43], v[80:83], v[208:211], v[40:43]
    ds_read_b64_tr_b16 v[78:79], v18 offset:37376
    s_waitcnt lgkmcnt(10)
    v_mfma_f32_16x16x32_bf16 v[52:55], v[84:87], v[212:215], v[52:55]
    ds_read_b64_tr_b16 v[80:81], v8 offset:38912
    s_cmp_lt_u32 s73, 3
    v_mfma_f32_16x16x32_bf16 v[44:47], v[84:87], v[208:211], v[44:47]
    ds_read_b64_tr_b16 v[82:83], v8 offset:39424
    s_waitcnt lgkmcnt(10)
    v_mfma_f32_16x16x32_bf16 v[60:63], v[212:215], v[88:91], v[60:63]
    ds_read_b64_tr_b16 v[84:85], v18 offset:38912
    s_cselect_b32 s88, s88, 0x40000000
    v_mfma_f32_16x16x32_bf16 v[56:59], v[208:211], v[88:91], v[56:59]
    ds_read_b64_tr_b16 v[86:87], v18 offset:39424
    s_waitcnt lgkmcnt(10)
    v_mfma_f32_16x16x32_bf16 v[68:71], v[212:215], v[92:95], v[68:71]
    ds_read_b64_tr_b16 v[88:89], v8 offset:40960
    s_lshl_b32 s85, s60, 14
    v_mfma_f32_16x16x32_bf16 v[64:67], v[208:211], v[92:95], v[64:67]
    ds_read_b64_tr_b16 v[90:91], v8 offset:41472
    s_waitcnt lgkmcnt(8)
    v_mfma_f32_16x16x32_bf16 v[32:35], v[72:75], v[220:223], v[32:35]
    ds_read_b64_tr_b16 v[92:93], v18 offset:40960
    s_lshl_b32 s72, s67, 7
    v_mfma_f32_16x16x32_bf16 v[24:27], v[72:75], v[216:219], v[24:27]
    ds_read_b64_tr_b16 v[94:95], v18 offset:41472
    s_waitcnt lgkmcnt(8)
    v_mfma_f32_16x16x32_bf16 v[36:39], v[76:79], v[220:223], v[36:39]
    s_barrier
    ds_read_b128 v[224:227], v16 offset:49152
    ds_read_b64_tr_b16 v[72:73], v9 offset:0
    s_add_u32 s85, s85, s72
    v_mfma_f32_16x16x32_bf16 v[28:31], v[76:79], v[216:219], v[28:31]
    ds_read_b128 v[228:231], v16 offset:51200
    ds_read_b64_tr_b16 v[74:75], v9 offset:512
    s_waitcnt lgkmcnt(10)
    v_mfma_f32_16x16x32_bf16 v[48:51], v[80:83], v[220:223], v[48:51]
    ds_read_b64_tr_b16 v[76:77], v19 offset:0
    s_lshl_b32 s86, s60, 6
    v_mfma_f32_16x16x32_bf16 v[40:43], v[80:83], v[216:219], v[40:43]
    ds_read_b64_tr_b16 v[78:79], v19 offset:512
    s_waitcnt lgkmcnt(10)
    v_mfma_f32_16x16x32_bf16 v[52:55], v[84:87], v[220:223], v[52:55]
    ds_read_b64_tr_b16 v[80:81], v9 offset:2048
    s_lshl1_add_u32 s86, s66, s86
    v_mfma_f32_16x16x32_bf16 v[44:47], v[84:87], v[216:219], v[44:47]
    ds_read_b64_tr_b16 v[82:83], v9 offset:2560
    s_waitcnt lgkmcnt(10)
    v_mfma_f32_16x16x32_bf16 v[60:63], v[220:223], v[88:91], v[60:63]
    ds_read_b64_tr_b16 v[84:85], v19 offset:2048
    s_lshl_b32 s86, s86, 10
    v_mfma_f32_16x16x32_bf16 v[56:59], v[216:219], v[88:91], v[56:59]
    ds_read_b64_tr_b16 v[86:87], v19 offset:2560
    s_waitcnt lgkmcnt(10)
    v_mfma_f32_16x16x32_bf16 v[68:71], v[220:223], v[92:95], v[68:71]
    ds_read_b64_tr_b16 v[88:89], v9 offset:4096
    s_add_u32 s86, s86, 7340032
    v_mfma_f32_16x16x32_bf16 v[64:67], v[216:219], v[92:95], v[64:67]
    ds_read_b64_tr_b16 v[90:91], v9 offset:4608
    s_waitcnt lgkmcnt(8)
    v_mfma_f32_16x16x32_bf16 v[32:35], v[72:75], v[228:231], v[32:35]
    ds_read_b64_tr_b16 v[92:93], v19 offset:4096
    s_lshl_b32 s87, s66, 9
    v_mfma_f32_16x16x32_bf16 v[24:27], v[72:75], v[224:227], v[24:27]
    ds_read_b64_tr_b16 v[94:95], v19 offset:4608
    s_waitcnt lgkmcnt(8)
    v_mfma_f32_16x16x32_bf16 v[36:39], v[76:79], v[228:231], v[36:39]
    ds_read_b128 v[232:235], v17 offset:49152
    ds_read_b64_tr_b16 v[72:73], v9 offset:12288
    s_add_u32 s87, s87, 393216
    v_mfma_f32_16x16x32_bf16 v[28:31], v[76:79], v[224:227], v[28:31]
    ds_read_b128 v[236:239], v17 offset:51200
    ds_read_b64_tr_b16 v[74:75], v9 offset:12800
    s_waitcnt lgkmcnt(10)
    v_mfma_f32_16x16x32_bf16 v[48:51], v[80:83], v[228:231], v[48:51]
    ds_read_b64_tr_b16 v[76:77], v19 offset:12288
    v_mfma_f32_16x16x32_bf16 v[40:43], v[80:83], v[224:227], v[40:43]
    ds_read_b64_tr_b16 v[78:79], v19 offset:12800
    s_waitcnt lgkmcnt(10)
    v_mfma_f32_16x16x32_bf16 v[52:55], v[84:87], v[228:231], v[52:55]
    ds_read_b64_tr_b16 v[80:81], v9 offset:14336
    v_mfma_f32_16x16x32_bf16 v[44:47], v[84:87], v[224:227], v[44:47]
    ds_read_b64_tr_b16 v[82:83], v9 offset:14848
    s_waitcnt lgkmcnt(10)
    v_mfma_f32_16x16x32_bf16 v[60:63], v[228:231], v[88:91], v[60:63]
    ds_read_b64_tr_b16 v[84:85], v19 offset:14336
    v_mfma_f32_16x16x32_bf16 v[56:59], v[224:227], v[88:91], v[56:59]
    ds_read_b64_tr_b16 v[86:87], v19 offset:14848
    s_waitcnt lgkmcnt(10)
    v_mfma_f32_16x16x32_bf16 v[68:71], v[228:231], v[92:95], v[68:71]
    ds_read_b64_tr_b16 v[88:89], v9 offset:16384
    v_mfma_f32_16x16x32_bf16 v[64:67], v[224:227], v[92:95], v[64:67]
    ds_read_b64_tr_b16 v[90:91], v9 offset:16896
    s_waitcnt lgkmcnt(8)
    v_mfma_f32_16x16x32_bf16 v[32:35], v[72:75], v[236:239], v[32:35]
    ds_read_b64_tr_b16 v[92:93], v19 offset:16384
    v_mfma_f32_16x16x32_bf16 v[24:27], v[72:75], v[232:235], v[24:27]
    ds_read_b64_tr_b16 v[94:95], v19 offset:16896
    s_waitcnt lgkmcnt(8)
    v_mfma_f32_16x16x32_bf16 v[36:39], v[76:79], v[236:239], v[36:39]
    s_barrier
    ds_read_b128 v[240:243], v16 offset:57344
    ds_read_b64_tr_b16 v[72:73], v9 offset:24576
    v_mfma_f32_16x16x32_bf16 v[28:31], v[76:79], v[232:235], v[28:31]
    ds_read_b128 v[244:247], v16 offset:59392
    ds_read_b64_tr_b16 v[74:75], v9 offset:25088
    s_waitcnt lgkmcnt(10)
    v_mfma_f32_16x16x32_bf16 v[48:51], v[80:83], v[236:239], v[48:51]
    ds_read_b64_tr_b16 v[76:77], v19 offset:24576
    v_mfma_f32_16x16x32_bf16 v[40:43], v[80:83], v[232:235], v[40:43]
    ds_read_b64_tr_b16 v[78:79], v19 offset:25088
    s_waitcnt lgkmcnt(10)
    v_mfma_f32_16x16x32_bf16 v[52:55], v[84:87], v[236:239], v[52:55]
    ds_read_b64_tr_b16 v[80:81], v9 offset:26624
    v_mfma_f32_16x16x32_bf16 v[44:47], v[84:87], v[232:235], v[44:47]
    ds_read_b64_tr_b16 v[82:83], v9 offset:27136
    s_waitcnt lgkmcnt(10)
    v_mfma_f32_16x16x32_bf16 v[60:63], v[236:239], v[88:91], v[60:63]
    ds_read_b64_tr_b16 v[84:85], v19 offset:26624
    v_mfma_f32_16x16x32_bf16 v[56:59], v[232:235], v[88:91], v[56:59]
    ds_read_b64_tr_b16 v[86:87], v19 offset:27136
    s_waitcnt lgkmcnt(10)
    v_mfma_f32_16x16x32_bf16 v[68:71], v[236:239], v[92:95], v[68:71]
    ds_read_b64_tr_b16 v[88:89], v9 offset:28672
    v_mfma_f32_16x16x32_bf16 v[64:67], v[232:235], v[92:95], v[64:67]
    ds_read_b64_tr_b16 v[90:91], v9 offset:29184
    s_waitcnt lgkmcnt(8)
    v_mfma_f32_16x16x32_bf16 v[32:35], v[72:75], v[244:247], v[32:35]
    ds_read_b64_tr_b16 v[92:93], v19 offset:28672
    v_mfma_f32_16x16x32_bf16 v[24:27], v[72:75], v[240:243], v[24:27]
    ds_read_b64_tr_b16 v[94:95], v19 offset:29184
    s_waitcnt lgkmcnt(8)
    v_mfma_f32_16x16x32_bf16 v[36:39], v[76:79], v[244:247], v[36:39]
    ds_read_b128 v[248:251], v17 offset:57344
    ds_read_b64_tr_b16 v[72:73], v9 offset:36864
    v_mfma_f32_16x16x32_bf16 v[28:31], v[76:79], v[240:243], v[28:31]
    ds_read_b128 v[252:255], v17 offset:59392
    ds_read_b64_tr_b16 v[74:75], v9 offset:37376
    s_waitcnt lgkmcnt(10)
    v_mfma_f32_16x16x32_bf16 v[48:51], v[80:83], v[244:247], v[48:51]
    ds_read_b64_tr_b16 v[76:77], v19 offset:36864
    v_mfma_f32_16x16x32_bf16 v[40:43], v[80:83], v[240:243], v[40:43]
    ds_read_b64_tr_b16 v[78:79], v19 offset:37376
    s_waitcnt lgkmcnt(10)
    v_mfma_f32_16x16x32_bf16 v[52:55], v[84:87], v[244:247], v[52:55]
    ds_read_b64_tr_b16 v[80:81], v9 offset:38912
    v_mfma_f32_16x16x32_bf16 v[44:47], v[84:87], v[240:243], v[44:47]
    ds_read_b64_tr_b16 v[82:83], v9 offset:39424
    s_waitcnt lgkmcnt(10)
    v_mfma_f32_16x16x32_bf16 v[60:63], v[244:247], v[88:91], v[60:63]
    ds_read_b64_tr_b16 v[84:85], v19 offset:38912
    v_mfma_f32_16x16x32_bf16 v[56:59], v[240:243], v[88:91], v[56:59]
    ds_read_b64_tr_b16 v[86:87], v19 offset:39424
    s_waitcnt lgkmcnt(10)
    v_mfma_f32_16x16x32_bf16 v[68:71], v[244:247], v[92:95], v[68:71]
    ds_read_b64_tr_b16 v[88:89], v9 offset:40960
    v_mfma_f32_16x16x32_bf16 v[64:67], v[240:243], v[92:95], v[64:67]
    ds_read_b64_tr_b16 v[90:91], v9 offset:41472
    s_waitcnt lgkmcnt(8)
    v_mfma_f32_16x16x32_bf16 v[32:35], v[72:75], v[252:255], v[32:35]
    ds_read_b64_tr_b16 v[92:93], v19 offset:40960
    v_mfma_f32_16x16x32_bf16 v[24:27], v[72:75], v[248:251], v[24:27]
    ds_read_b64_tr_b16 v[94:95], v19 offset:41472
    s_waitcnt lgkmcnt(8)
    v_mfma_f32_16x16x32_bf16 v[36:39], v[76:79], v[252:255], v[36:39]
    v_mfma_f32_16x16x32_bf16 v[28:31], v[76:79], v[248:251], v[28:31]
    s_waitcnt lgkmcnt(6)
    v_mfma_f32_16x16x32_bf16 v[48:51], v[80:83], v[252:255], v[48:51]
    v_mfma_f32_16x16x32_bf16 v[40:43], v[80:83], v[248:251], v[40:43]
    s_waitcnt lgkmcnt(4)
    v_mfma_f32_16x16x32_bf16 v[52:55], v[84:87], v[252:255], v[52:55]
    v_mfma_f32_16x16x32_bf16 v[44:47], v[84:87], v[248:251], v[44:47]
    s_waitcnt lgkmcnt(2)
    v_mfma_f32_16x16x32_bf16 v[60:63], v[252:255], v[88:91], v[60:63]
    v_mfma_f32_16x16x32_bf16 v[56:59], v[248:251], v[88:91], v[56:59]
    s_waitcnt lgkmcnt(0)
    v_mfma_f32_16x16x32_bf16 v[68:71], v[252:255], v[92:95], v[68:71]
    v_mfma_f32_16x16x32_bf16 v[64:67], v[248:251], v[92:95], v[64:67]
    v_mul_f32 v24, 0x3eb8aa3b, v24
    v_mul_f32 v25, 0x3eb8aa3b, v25
    v_mul_f32 v26, 0x3eb8aa3b, v26
    v_mul_f32 v27, 0x3eb8aa3b, v27
    v_mul_f32 v28, 0x3eb8aa3b, v28
    v_mul_f32 v29, 0x3eb8aa3b, v29
    v_mul_f32 v30, 0x3eb8aa3b, v30
    v_mul_f32 v31, 0x3eb8aa3b, v31
    v_mul_f32 v32, 0x3eb8aa3b, v32
    v_mul_f32 v33, 0x3eb8aa3b, v33
    v_mul_f32 v34, 0x3eb8aa3b, v34
    v_mul_f32 v35, 0x3eb8aa3b, v35
    v_mul_f32 v36, 0x3eb8aa3b, v36
    v_mul_f32 v37, 0x3eb8aa3b, v37
    v_mul_f32 v38, 0x3eb8aa3b, v38
    v_mul_f32 v39, 0x3eb8aa3b, v39
    v_cvt_pk_bf16_f32 v96, v24, v25
    v_cvt_pk_bf16_f32 v97, v26, v27
    v_cvt_pk_bf16_f32 v98, v28, v29
    v_cvt_pk_bf16_f32 v99, v30, v31
    v_cvt_pk_bf16_f32 v100, v32, v33
    v_cvt_pk_bf16_f32 v101, v34, v35
    v_cvt_pk_bf16_f32 v102, v36, v37
    v_cvt_pk_bf16_f32 v103, v38, v39
    v_or_b32 v96, 1, v96
    v_or_b32 v100, 1, v100
    buffer_store_dwordx4 v[96:99], v14, s[56:59], s76 offen offset:0 sc1
    buffer_store_dwordx4 v[100:103], v14, s[56:59], s76 offen offset:256 sc1
    v_cvt_pk_bf16_f32 v104, v40, v41
    v_cvt_pk_bf16_f32 v105, v42, v43
    v_cvt_pk_bf16_f32 v106, v44, v45
    v_cvt_pk_bf16_f32 v107, v46, v47
    v_cvt_pk_bf16_f32 v108, v48, v49
    v_cvt_pk_bf16_f32 v109, v50, v51
    v_cvt_pk_bf16_f32 v110, v52, v53
    v_cvt_pk_bf16_f32 v111, v54, v55
    buffer_store_dwordx4 v[104:107], v11, s[56:59], s77 offen offset:0 sc1
    buffer_store_dwordx4 v[108:111], v11, s[56:59], s77 offen offset:256 sc1
    v_cvt_pk_bf16_f32 v96, v56, v57
    v_cvt_pk_bf16_f32 v97, v58, v59
    v_cvt_pk_bf16_f32 v98, v60, v61
    v_cvt_pk_bf16_f32 v99, v62, v63
    v_cvt_pk_bf16_f32 v100, v64, v65
    v_cvt_pk_bf16_f32 v101, v66, v67
    v_cvt_pk_bf16_f32 v102, v68, v69
    v_cvt_pk_bf16_f32 v103, v70, v71
    buffer_store_dwordx4 v[96:99], v12, s[56:59], s77 offen offset:1024 sc1
    buffer_store_dwordx4 v[100:103], v12, s[56:59], s77 offen offset:1152 sc1
    v_lshlrev_b32 v24, 16, v112
    v_and_b32 v25, s89, v112
    v_lshlrev_b32 v26, 16, v113
    v_and_b32 v27, s89, v113
    v_lshlrev_b32 v28, 16, v114
    v_and_b32 v29, s89, v114
    v_lshlrev_b32 v30, 16, v115
    v_and_b32 v31, s89, v115
    v_lshlrev_b32 v40, 16, v116
    v_and_b32 v41, s89, v116
    v_lshlrev_b32 v42, 16, v117
    v_and_b32 v43, s89, v117
    v_lshlrev_b32 v44, 16, v118
    v_and_b32 v45, s89, v118
    v_lshlrev_b32 v46, 16, v119
    v_and_b32 v47, s89, v119
    v_lshlrev_b32 v56, 16, v120
    v_and_b32 v57, s89, v120
    v_lshlrev_b32 v58, 16, v121
    v_and_b32 v59, s89, v121
    v_lshlrev_b32 v60, 16, v122
    v_and_b32 v61, s89, v122
    v_lshlrev_b32 v62, 16, v123
    v_and_b32 v63, s89, v123
    s_barrier
    ds_read_b64_tr_b16 v[72:73], v8 offset:0
    ds_read_b64_tr_b16 v[74:75], v8 offset:512
    ds_read_b64_tr_b16 v[76:77], v18 offset:0
    ds_read_b64_tr_b16 v[78:79], v18 offset:512
    ds_read_b64_tr_b16 v[80:81], v8 offset:2048
    ds_read_b64_tr_b16 v[82:83], v8 offset:2560
    ds_read_b64_tr_b16 v[84:85], v18 offset:2048
    ds_read_b64_tr_b16 v[86:87], v18 offset:2560
    ds_read_b64_tr_b16 v[88:89], v8 offset:4096
    ds_read_b64_tr_b16 v[90:91], v8 offset:4608
    s_waitcnt lgkmcnt(8)
    v_mfma_f32_16x16x32_bf16 v[32:35], v[72:75], v[132:135], v[24:27]
    ds_read_b64_tr_b16 v[92:93], v18 offset:4096
    v_mfma_f32_16x16x32_bf16 v[24:27], v[72:75], v[128:131], v[24:27]
    ds_read_b64_tr_b16 v[94:95], v18 offset:4608
    s_waitcnt lgkmcnt(8)
    v_mfma_f32_16x16x32_bf16 v[36:39], v[76:79], v[132:135], v[28:31]
    ds_read_b64_tr_b16 v[72:73], v8 offset:12288
    v_mfma_f32_16x16x32_bf16 v[28:31], v[76:79], v[128:131], v[28:31]
    ds_read_b64_tr_b16 v[74:75], v8 offset:12800
    s_waitcnt lgkmcnt(8)
    v_mfma_f32_16x16x32_bf16 v[48:51], v[80:83], v[132:135], v[40:43]
    ds_read_b64_tr_b16 v[76:77], v18 offset:12288
    v_mfma_f32_16x16x32_bf16 v[40:43], v[80:83], v[128:131], v[40:43]
    ds_read_b64_tr_b16 v[78:79], v18 offset:12800
    s_waitcnt lgkmcnt(8)
    v_mfma_f32_16x16x32_bf16 v[52:55], v[84:87], v[132:135], v[44:47]
    ds_read_b64_tr_b16 v[80:81], v8 offset:14336
    v_mfma_f32_16x16x32_bf16 v[44:47], v[84:87], v[128:131], v[44:47]
    ds_read_b64_tr_b16 v[82:83], v8 offset:14848
    s_waitcnt lgkmcnt(8)
    v_mfma_f32_16x16x32_bf16 v[64:67], v[88:91], v[132:135], v[56:59]
    ds_read_b64_tr_b16 v[84:85], v18 offset:14336
    v_mfma_f32_16x16x32_bf16 v[56:59], v[88:91], v[128:131], v[56:59]
    ds_read_b64_tr_b16 v[86:87], v18 offset:14848
    s_waitcnt lgkmcnt(8)
    v_mfma_f32_16x16x32_bf16 v[68:71], v[92:95], v[132:135], v[60:63]
    ds_read_b64_tr_b16 v[88:89], v8 offset:16384
    v_mfma_f32_16x16x32_bf16 v[60:63], v[92:95], v[128:131], v[60:63]
    ds_read_b64_tr_b16 v[90:91], v8 offset:16896
    s_waitcnt lgkmcnt(8)
    v_mfma_f32_16x16x32_bf16 v[32:35], v[72:75], v[140:143], v[32:35]
    ds_read_b64_tr_b16 v[92:93], v18 offset:16384
    v_mfma_f32_16x16x32_bf16 v[24:27], v[72:75], v[136:139], v[24:27]
    ds_read_b64_tr_b16 v[94:95], v18 offset:16896
    s_waitcnt lgkmcnt(8)
    v_mfma_f32_16x16x32_bf16 v[36:39], v[76:79], v[140:143], v[36:39]
    s_waitcnt vmcnt(0)
    s_barrier
    s_cmp_lg_u32 s60, 0
    s_cselect_b32 s79, 0x40000000, s79
    v_mov_b32 v7, s68
    s_mov_b64 exec, 1
    buffer_store_dword v7, v1, s[56:59], s79 offen offset:0 sc0 sc1
    s_mov_b64 exec, -1
    ds_read_b64_tr_b16 v[72:73], v8 offset:24576
    v_mfma_f32_16x16x32_bf16 v[28:31], v[76:79], v[136:139], v[28:31]
    ds_read_b64_tr_b16 v[74:75], v8 offset:25088
    s_waitcnt lgkmcnt(8)
    v_mfma_f32_16x16x32_bf16 v[48:51], v[80:83], v[140:143], v[48:51]
    ds_read_b64_tr_b16 v[76:77], v18 offset:24576
    v_mfma_f32_16x16x32_bf16 v[40:43], v[80:83], v[136:139], v[40:43]
    ds_read_b64_tr_b16 v[78:79], v18 offset:25088
    s_waitcnt lgkmcnt(8)
    v_mfma_f32_16x16x32_bf16 v[52:55], v[84:87], v[140:143], v[52:55]
    ds_read_b64_tr_b16 v[80:81], v8 offset:26624
    v_mfma_f32_16x16x32_bf16 v[44:47], v[84:87], v[136:139], v[44:47]
    ds_read_b64_tr_b16 v[82:83], v8 offset:27136
    s_waitcnt lgkmcnt(8)
    v_mfma_f32_16x16x32_bf16 v[64:67], v[88:91], v[140:143], v[64:67]
    ds_read_b64_tr_b16 v[84:85], v18 offset:26624
    v_mfma_f32_16x16x32_bf16 v[56:59], v[88:91], v[136:139], v[56:59]
    ds_read_b64_tr_b16 v[86:87], v18 offset:27136
    s_waitcnt lgkmcnt(8)
    v_mfma_f32_16x16x32_bf16 v[68:71], v[92:95], v[140:143], v[68:71]
    ds_read_b64_tr_b16 v[88:89], v8 offset:28672
    v_mfma_f32_16x16x32_bf16 v[60:63], v[92:95], v[136:139], v[60:63]
    ds_read_b64_tr_b16 v[90:91], v8 offset:29184
    s_waitcnt lgkmcnt(8)
    v_mfma_f32_16x16x32_bf16 v[32:35], v[72:75], v[148:151], v[32:35]
    ds_read_b64_tr_b16 v[92:93], v18 offset:28672
    v_mov_b32 v128, 0
    v_mfma_f32_16x16x32_bf16 v[24:27], v[72:75], v[144:147], v[24:27]
    ds_read_b64_tr_b16 v[94:95], v18 offset:29184
    v_mov_b32 v129, 0
    s_waitcnt lgkmcnt(8)
    v_mfma_f32_16x16x32_bf16 v[36:39], v[76:79], v[148:151], v[36:39]
    ds_read_b64_tr_b16 v[72:73], v8 offset:36864
    v_mov_b32 v130, 0
    v_mfma_f32_16x16x32_bf16 v[28:31], v[76:79], v[144:147], v[28:31]
    ds_read_b64_tr_b16 v[74:75], v8 offset:37376
    v_mov_b32 v131, 0
    s_waitcnt lgkmcnt(8)
    v_mfma_f32_16x16x32_bf16 v[48:51], v[80:83], v[148:151], v[48:51]
    ds_read_b64_tr_b16 v[76:77], v18 offset:36864
    v_mov_b32 v132, 0
    v_mfma_f32_16x16x32_bf16 v[40:43], v[80:83], v[144:147], v[40:43]
    ds_read_b64_tr_b16 v[78:79], v18 offset:37376
    v_mov_b32 v133, 0
    s_waitcnt lgkmcnt(8)
    v_mfma_f32_16x16x32_bf16 v[52:55], v[84:87], v[148:151], v[52:55]
    ds_read_b64_tr_b16 v[80:81], v8 offset:38912
    v_mov_b32 v134, 0
    v_mfma_f32_16x16x32_bf16 v[44:47], v[84:87], v[144:147], v[44:47]
    ds_read_b64_tr_b16 v[82:83], v8 offset:39424
    v_mov_b32 v135, 0
    s_waitcnt lgkmcnt(8)
    v_mfma_f32_16x16x32_bf16 v[64:67], v[88:91], v[148:151], v[64:67]
    ds_read_b64_tr_b16 v[84:85], v18 offset:38912
    v_mov_b32 v136, 0
    v_mfma_f32_16x16x32_bf16 v[56:59], v[88:91], v[144:147], v[56:59]
    ds_read_b64_tr_b16 v[86:87], v18 offset:39424
    v_mov_b32 v137, 0
    s_waitcnt lgkmcnt(8)
    v_mfma_f32_16x16x32_bf16 v[68:71], v[92:95], v[148:151], v[68:71]
    ds_read_b64_tr_b16 v[88:89], v8 offset:40960
    v_mov_b32 v138, 0
    v_mfma_f32_16x16x32_bf16 v[60:63], v[92:95], v[144:147], v[60:63]
    ds_read_b64_tr_b16 v[90:91], v8 offset:41472
    v_mov_b32 v139, 0
    s_waitcnt lgkmcnt(8)
    v_mfma_f32_16x16x32_bf16 v[32:35], v[72:75], v[156:159], v[32:35]
    ds_read_b64_tr_b16 v[92:93], v18 offset:40960
    v_mov_b32 v140, 0
    v_mfma_f32_16x16x32_bf16 v[24:27], v[72:75], v[152:155], v[24:27]
    ds_read_b64_tr_b16 v[94:95], v18 offset:41472
    v_mov_b32 v141, 0
    s_waitcnt lgkmcnt(8)
    v_mfma_f32_16x16x32_bf16 v[36:39], v[76:79], v[156:159], v[36:39]
    s_barrier
    ds_read_b64_tr_b16 v[72:73], v9 offset:0
    v_mov_b32 v142, 0
    v_mfma_f32_16x16x32_bf16 v[28:31], v[76:79], v[152:155], v[28:31]
    ds_read_b64_tr_b16 v[74:75], v9 offset:512
    v_mov_b32 v143, 0
    s_waitcnt lgkmcnt(8)
    v_mfma_f32_16x16x32_bf16 v[48:51], v[80:83], v[156:159], v[48:51]
    ds_read_b64_tr_b16 v[76:77], v19 offset:0
    v_mfma_f32_16x16x32_bf16 v[40:43], v[80:83], v[152:155], v[40:43]
    ds_read_b64_tr_b16 v[78:79], v19 offset:512
    s_waitcnt lgkmcnt(8)
    v_mfma_f32_16x16x32_bf16 v[52:55], v[84:87], v[156:159], v[52:55]
    ds_read_b64_tr_b16 v[80:81], v9 offset:2048
    v_mfma_f32_16x16x32_bf16 v[44:47], v[84:87], v[152:155], v[44:47]
    ds_read_b64_tr_b16 v[82:83], v9 offset:2560
    s_waitcnt lgkmcnt(8)
    v_mfma_f32_16x16x32_bf16 v[64:67], v[88:91], v[156:159], v[64:67]
    ds_read_b64_tr_b16 v[84:85], v19 offset:2048
    v_mfma_f32_16x16x32_bf16 v[56:59], v[88:91], v[152:155], v[56:59]
    ds_read_b64_tr_b16 v[86:87], v19 offset:2560
    s_waitcnt lgkmcnt(8)
    v_mfma_f32_16x16x32_bf16 v[68:71], v[92:95], v[156:159], v[68:71]
    ds_read_b64_tr_b16 v[88:89], v9 offset:4096
    v_mfma_f32_16x16x32_bf16 v[60:63], v[92:95], v[152:155], v[60:63]
    ds_read_b64_tr_b16 v[90:91], v9 offset:4608
    s_waitcnt lgkmcnt(8)
    v_mfma_f32_16x16x32_bf16 v[32:35], v[72:75], v[164:167], v[32:35]
    ds_read_b64_tr_b16 v[92:93], v19 offset:4096
    v_mov_b32 v144, 0
    v_mfma_f32_16x16x32_bf16 v[24:27], v[72:75], v[160:163], v[24:27]
    ds_read_b64_tr_b16 v[94:95], v19 offset:4608
    v_mov_b32 v145, 0
    s_waitcnt lgkmcnt(8)
    v_mfma_f32_16x16x32_bf16 v[36:39], v[76:79], v[164:167], v[36:39]
    ds_read_b64_tr_b16 v[72:73], v9 offset:12288
    v_mov_b32 v146, 0
    v_mfma_f32_16x16x32_bf16 v[28:31], v[76:79], v[160:163], v[28:31]
    ds_read_b64_tr_b16 v[74:75], v9 offset:12800
    v_mov_b32 v147, 0
    s_waitcnt lgkmcnt(8)
    v_mfma_f32_16x16x32_bf16 v[48:51], v[80:83], v[164:167], v[48:51]
    ds_read_b64_tr_b16 v[76:77], v19 offset:12288
    v_mov_b32 v148, 0
    v_mfma_f32_16x16x32_bf16 v[40:43], v[80:83], v[160:163], v[40:43]
    ds_read_b64_tr_b16 v[78:79], v19 offset:12800
    v_mov_b32 v149, 0
    s_waitcnt lgkmcnt(8)
    v_mfma_f32_16x16x32_bf16 v[52:55], v[84:87], v[164:167], v[52:55]
    ds_read_b64_tr_b16 v[80:81], v9 offset:14336
    v_mov_b32 v150, 0
    v_mfma_f32_16x16x32_bf16 v[44:47], v[84:87], v[160:163], v[44:47]
    ds_read_b64_tr_b16 v[82:83], v9 offset:14848
    v_mov_b32 v151, 0
    s_waitcnt lgkmcnt(8)
    v_mfma_f32_16x16x32_bf16 v[64:67], v[88:91], v[164:167], v[64:67]
    ds_read_b64_tr_b16 v[84:85], v19 offset:14336
    v_mov_b32 v152, 0
    v_mfma_f32_16x16x32_bf16 v[56:59], v[88:91], v[160:163], v[56:59]
    ds_read_b64_tr_b16 v[86:87], v19 offset:14848
    v_mov_b32 v153, 0
    s_waitcnt lgkmcnt(8)
    v_mfma_f32_16x16x32_bf16 v[68:71], v[92:95], v[164:167], v[68:71]
    ds_read_b64_tr_b16 v[88:89], v9 offset:16384
    v_mov_b32 v154, 0
    v_mfma_f32_16x16x32_bf16 v[60:63], v[92:95], v[160:163], v[60:63]
    ds_read_b64_tr_b16 v[90:91], v9 offset:16896
    v_mov_b32 v155, 0
    s_waitcnt lgkmcnt(8)
    v_mfma_f32_16x16x32_bf16 v[32:35], v[72:75], v[172:175], v[32:35]
    ds_read_b64_tr_b16 v[92:93], v19 offset:16384
    v_mov_b32 v156, 0
    v_mfma_f32_16x16x32_bf16 v[24:27], v[72:75], v[168:171], v[24:27]
    ds_read_b64_tr_b16 v[94:95], v19 offset:16896
    v_mov_b32 v157, 0
    s_waitcnt lgkmcnt(8)
    v_mfma_f32_16x16x32_bf16 v[36:39], v[76:79], v[172:175], v[36:39]
    s_barrier
    ds_read_b64_tr_b16 v[72:73], v9 offset:24576
    v_mov_b32 v158, 0
    v_mfma_f32_16x16x32_bf16 v[28:31], v[76:79], v[168:171], v[28:31]
    ds_read_b64_tr_b16 v[74:75], v9 offset:25088
    v_mov_b32 v159, 0
    s_waitcnt lgkmcnt(8)
    v_mfma_f32_16x16x32_bf16 v[48:51], v[80:83], v[172:175], v[48:51]
    ds_read_b64_tr_b16 v[76:77], v19 offset:24576
    v_mfma_f32_16x16x32_bf16 v[40:43], v[80:83], v[168:171], v[40:43]
    ds_read_b64_tr_b16 v[78:79], v19 offset:25088
    s_waitcnt lgkmcnt(8)
    v_mfma_f32_16x16x32_bf16 v[52:55], v[84:87], v[172:175], v[52:55]
    ds_read_b64_tr_b16 v[80:81], v9 offset:26624
    v_mfma_f32_16x16x32_bf16 v[44:47], v[84:87], v[168:171], v[44:47]
    ds_read_b64_tr_b16 v[82:83], v9 offset:27136
    s_waitcnt lgkmcnt(8)
    v_mfma_f32_16x16x32_bf16 v[64:67], v[88:91], v[172:175], v[64:67]
    ds_read_b64_tr_b16 v[84:85], v19 offset:26624
    v_mfma_f32_16x16x32_bf16 v[56:59], v[88:91], v[168:171], v[56:59]
    ds_read_b64_tr_b16 v[86:87], v19 offset:27136
    s_waitcnt lgkmcnt(8)
    v_mfma_f32_16x16x32_bf16 v[68:71], v[92:95], v[172:175], v[68:71]
    ds_read_b64_tr_b16 v[88:89], v9 offset:28672
    v_mfma_f32_16x16x32_bf16 v[60:63], v[92:95], v[168:171], v[60:63]
    ds_read_b64_tr_b16 v[90:91], v9 offset:29184
    s_waitcnt lgkmcnt(8)
    v_mfma_f32_16x16x32_bf16 v[32:35], v[72:75], v[180:183], v[32:35]
    ds_read_b64_tr_b16 v[92:93], v19 offset:28672
    v_mov_b32 v160, 0
    v_mfma_f32_16x16x32_bf16 v[24:27], v[72:75], v[176:179], v[24:27]
    ds_read_b64_tr_b16 v[94:95], v19 offset:29184
    v_mov_b32 v161, 0
    s_waitcnt lgkmcnt(8)
    v_mfma_f32_16x16x32_bf16 v[36:39], v[76:79], v[180:183], v[36:39]
    ds_read_b64_tr_b16 v[72:73], v9 offset:36864
    v_mov_b32 v162, 0
    v_mfma_f32_16x16x32_bf16 v[28:31], v[76:79], v[176:179], v[28:31]
    ds_read_b64_tr_b16 v[74:75], v9 offset:37376
    v_mov_b32 v163, 0
    s_waitcnt lgkmcnt(8)
    v_mfma_f32_16x16x32_bf16 v[48:51], v[80:83], v[180:183], v[48:51]
    ds_read_b64_tr_b16 v[76:77], v19 offset:36864
    v_mov_b32 v164, 0
    v_mfma_f32_16x16x32_bf16 v[40:43], v[80:83], v[176:179], v[40:43]
    ds_read_b64_tr_b16 v[78:79], v19 offset:37376
    v_mov_b32 v165, 0
    s_waitcnt lgkmcnt(8)
    v_mfma_f32_16x16x32_bf16 v[52:55], v[84:87], v[180:183], v[52:55]
    ds_read_b64_tr_b16 v[80:81], v9 offset:38912
    v_mov_b32 v166, 0
    v_mfma_f32_16x16x32_bf16 v[44:47], v[84:87], v[176:179], v[44:47]
    ds_read_b64_tr_b16 v[82:83], v9 offset:39424
    v_mov_b32 v167, 0
    s_waitcnt lgkmcnt(8)
    v_mfma_f32_16x16x32_bf16 v[64:67], v[88:91], v[180:183], v[64:67]
    ds_read_b64_tr_b16 v[84:85], v19 offset:38912
    v_mov_b32 v168, 0
    v_mfma_f32_16x16x32_bf16 v[56:59], v[88:91], v[176:179], v[56:59]
    ds_read_b64_tr_b16 v[86:87], v19 offset:39424
    v_mov_b32 v169, 0
    s_waitcnt lgkmcnt(8)
    v_mfma_f32_16x16x32_bf16 v[68:71], v[92:95], v[180:183], v[68:71]
    ds_read_b64_tr_b16 v[88:89], v9 offset:40960
    v_mov_b32 v170, 0
    v_mfma_f32_16x16x32_bf16 v[60:63], v[92:95], v[176:179], v[60:63]
    ds_read_b64_tr_b16 v[90:91], v9 offset:41472
    v_mov_b32 v171, 0
    s_waitcnt lgkmcnt(8)
    v_mfma_f32_16x16x32_bf16 v[32:35], v[72:75], v[188:191], v[32:35]
    ds_read_b64_tr_b16 v[92:93], v19 offset:40960
    v_mov_b32 v172, 0
    v_mfma_f32_16x16x32_bf16 v[24:27], v[72:75], v[184:187], v[24:27]
    ds_read_b64_tr_b16 v[94:95], v19 offset:41472
    v_mov_b32 v173, 0
    s_waitcnt lgkmcnt(8)
    v_mfma_f32_16x16x32_bf16 v[36:39], v[76:79], v[188:191], v[36:39]
    s_barrier
    ds_read_b64_tr_b16 v[72:73], v8 offset:0
    v_mov_b32 v174, 0
    v_mfma_f32_16x16x32_bf16 v[28:31], v[76:79], v[184:187], v[28:31]
    ds_read_b64_tr_b16 v[74:75], v8 offset:512
    v_mov_b32 v175, 0
    s_waitcnt lgkmcnt(8)
    v_mfma_f32_16x16x32_bf16 v[48:51], v[80:83], v[188:191], v[48:51]
    ds_read_b64_tr_b16 v[76:77], v18 offset:0
    v_mfma_f32_16x16x32_bf16 v[40:43], v[80:83], v[184:187], v[40:43]
    ds_read_b64_tr_b16 v[78:79], v18 offset:512
    s_waitcnt lgkmcnt(8)
    v_mfma_f32_16x16x32_bf16 v[52:55], v[84:87], v[188:191], v[52:55]
    ds_read_b64_tr_b16 v[80:81], v8 offset:2048
    v_mfma_f32_16x16x32_bf16 v[44:47], v[84:87], v[184:187], v[44:47]
    ds_read_b64_tr_b16 v[82:83], v8 offset:2560
    s_waitcnt lgkmcnt(8)
    v_mfma_f32_16x16x32_bf16 v[64:67], v[88:91], v[188:191], v[64:67]
    ds_read_b64_tr_b16 v[84:85], v18 offset:2048
    v_mfma_f32_16x16x32_bf16 v[56:59], v[88:91], v[184:187], v[56:59]
    ds_read_b64_tr_b16 v[86:87], v18 offset:2560
    s_waitcnt lgkmcnt(8)
    v_mfma_f32_16x16x32_bf16 v[68:71], v[92:95], v[188:191], v[68:71]
    ds_read_b64_tr_b16 v[88:89], v8 offset:4096
    v_mfma_f32_16x16x32_bf16 v[60:63], v[92:95], v[184:187], v[60:63]
    ds_read_b64_tr_b16 v[90:91], v8 offset:4608
    s_waitcnt lgkmcnt(8)
    v_mfma_f32_16x16x32_bf16 v[32:35], v[72:75], v[196:199], v[32:35]
    ds_read_b64_tr_b16 v[92:93], v18 offset:4096
    v_mov_b32 v176, 0
    v_mfma_f32_16x16x32_bf16 v[24:27], v[72:75], v[192:195], v[24:27]
    ds_read_b64_tr_b16 v[94:95], v18 offset:4608
    v_mov_b32 v177, 0
    s_waitcnt lgkmcnt(8)
    v_mfma_f32_16x16x32_bf16 v[36:39], v[76:79], v[196:199], v[36:39]
    ds_read_b64_tr_b16 v[72:73], v8 offset:12288
    v_mov_b32 v178, 0
    v_mfma_f32_16x16x32_bf16 v[28:31], v[76:79], v[192:195], v[28:31]
    ds_read_b64_tr_b16 v[74:75], v8 offset:12800
    v_mov_b32 v179, 0
    s_waitcnt lgkmcnt(8)
    v_mfma_f32_16x16x32_bf16 v[48:51], v[80:83], v[196:199], v[48:51]
    ds_read_b64_tr_b16 v[76:77], v18 offset:12288
    v_mov_b32 v180, 0
    v_mfma_f32_16x16x32_bf16 v[40:43], v[80:83], v[192:195], v[40:43]
    ds_read_b64_tr_b16 v[78:79], v18 offset:12800
    v_mov_b32 v181, 0
    s_waitcnt lgkmcnt(8)
    v_mfma_f32_16x16x32_bf16 v[52:55], v[84:87], v[196:199], v[52:55]
    ds_read_b64_tr_b16 v[80:81], v8 offset:14336
    v_mov_b32 v182, 0
    v_mfma_f32_16x16x32_bf16 v[44:47], v[84:87], v[192:195], v[44:47]
    ds_read_b64_tr_b16 v[82:83], v8 offset:14848
    v_mov_b32 v183, 0
    s_waitcnt lgkmcnt(8)
    v_mfma_f32_16x16x32_bf16 v[64:67], v[88:91], v[196:199], v[64:67]
    ds_read_b64_tr_b16 v[84:85], v18 offset:14336
    v_mov_b32 v184, 0
    v_mfma_f32_16x16x32_bf16 v[56:59], v[88:91], v[192:195], v[56:59]
    ds_read_b64_tr_b16 v[86:87], v18 offset:14848
    v_mov_b32 v185, 0
    s_waitcnt lgkmcnt(8)
    v_mfma_f32_16x16x32_bf16 v[68:71], v[92:95], v[196:199], v[68:71]
    ds_read_b64_tr_b16 v[88:89], v8 offset:16384
    v_mov_b32 v186, 0
    v_mfma_f32_16x16x32_bf16 v[60:63], v[92:95], v[192:195], v[60:63]
    ds_read_b64_tr_b16 v[90:91], v8 offset:16896
    v_mov_b32 v187, 0
    s_waitcnt lgkmcnt(8)
    v_mfma_f32_16x16x32_bf16 v[32:35], v[72:75], v[204:207], v[32:35]
    ds_read_b64_tr_b16 v[92:93], v18 offset:16384
    v_mov_b32 v188, 0
    v_mfma_f32_16x16x32_bf16 v[24:27], v[72:75], v[200:203], v[24:27]
    ds_read_b64_tr_b16 v[94:95], v18 offset:16896
    v_mov_b32 v189, 0
    s_waitcnt lgkmcnt(8)
    v_mfma_f32_16x16x32_bf16 v[36:39], v[76:79], v[204:207], v[36:39]
    s_barrier
    ds_read_b64_tr_b16 v[72:73], v8 offset:24576
    v_mov_b32 v190, 0
    v_mfma_f32_16x16x32_bf16 v[28:31], v[76:79], v[200:203], v[28:31]
    ds_read_b64_tr_b16 v[74:75], v8 offset:25088
    v_mov_b32 v191, 0
    s_waitcnt lgkmcnt(8)
    v_mfma_f32_16x16x32_bf16 v[48:51], v[80:83], v[204:207], v[48:51]
    ds_read_b64_tr_b16 v[76:77], v18 offset:24576
    v_mfma_f32_16x16x32_bf16 v[40:43], v[80:83], v[200:203], v[40:43]
    ds_read_b64_tr_b16 v[78:79], v18 offset:25088
    s_waitcnt lgkmcnt(8)
    v_mfma_f32_16x16x32_bf16 v[52:55], v[84:87], v[204:207], v[52:55]
    ds_read_b64_tr_b16 v[80:81], v8 offset:26624
    v_mfma_f32_16x16x32_bf16 v[44:47], v[84:87], v[200:203], v[44:47]
    ds_read_b64_tr_b16 v[82:83], v8 offset:27136
    s_waitcnt lgkmcnt(8)
    v_mfma_f32_16x16x32_bf16 v[64:67], v[88:91], v[204:207], v[64:67]
    ds_read_b64_tr_b16 v[84:85], v18 offset:26624
    v_mfma_f32_16x16x32_bf16 v[56:59], v[88:91], v[200:203], v[56:59]
    ds_read_b64_tr_b16 v[86:87], v18 offset:27136
    s_waitcnt lgkmcnt(8)
    v_mfma_f32_16x16x32_bf16 v[68:71], v[92:95], v[204:207], v[68:71]
    ds_read_b64_tr_b16 v[88:89], v8 offset:28672
    v_mfma_f32_16x16x32_bf16 v[60:63], v[92:95], v[200:203], v[60:63]
    ds_read_b64_tr_b16 v[90:91], v8 offset:29184
    s_waitcnt lgkmcnt(8)
    v_mfma_f32_16x16x32_bf16 v[32:35], v[72:75], v[212:215], v[32:35]
    ds_read_b64_tr_b16 v[92:93], v18 offset:28672
    v_mfma_f32_16x16x32_bf16 v[24:27], v[72:75], v[208:211], v[24:27]
    ds_read_b64_tr_b16 v[94:95], v18 offset:29184
    s_waitcnt lgkmcnt(8)
    v_mfma_f32_16x16x32_bf16 v[36:39], v[76:79], v[212:215], v[36:39]
    ds_read_b64_tr_b16 v[72:73], v8 offset:36864
    v_mfma_f32_16x16x32_bf16 v[28:31], v[76:79], v[208:211], v[28:31]
    ds_read_b64_tr_b16 v[74:75], v8 offset:37376
    s_waitcnt lgkmcnt(8)
    v_mfma_f32_16x16x32_bf16 v[48:51], v[80:83], v[212:215], v[48:51]
    ds_read_b64_tr_b16 v[76:77], v18 offset:36864
    v_mfma_f32_16x16x32_bf16 v[40:43], v[80:83], v[208:211], v[40:43]
    ds_read_b64_tr_b16 v[78:79], v18 offset:37376
    s_waitcnt lgkmcnt(8)
    v_mfma_f32_16x16x32_bf16 v[52:55], v[84:87], v[212:215], v[52:55]
    ds_read_b64_tr_b16 v[80:81], v8 offset:38912
    v_mfma_f32_16x16x32_bf16 v[44:47], v[84:87], v[208:211], v[44:47]
    ds_read_b64_tr_b16 v[82:83], v8 offset:39424
    s_waitcnt lgkmcnt(8)
    v_mfma_f32_16x16x32_bf16 v[64:67], v[88:91], v[212:215], v[64:67]
    ds_read_b64_tr_b16 v[84:85], v18 offset:38912
    v_mfma_f32_16x16x32_bf16 v[56:59], v[88:91], v[208:211], v[56:59]
    ds_read_b64_tr_b16 v[86:87], v18 offset:39424
    s_waitcnt lgkmcnt(8)
    v_mfma_f32_16x16x32_bf16 v[68:71], v[92:95], v[212:215], v[68:71]
    ds_read_b64_tr_b16 v[88:89], v8 offset:40960
    v_mfma_f32_16x16x32_bf16 v[60:63], v[92:95], v[208:211], v[60:63]
    ds_read_b64_tr_b16 v[90:91], v8 offset:41472
    s_waitcnt lgkmcnt(8)
    v_mfma_f32_16x16x32_bf16 v[32:35], v[72:75], v[220:223], v[32:35]
    ds_read_b64_tr_b16 v[92:93], v18 offset:40960
    v_mfma_f32_16x16x32_bf16 v[24:27], v[72:75], v[216:219], v[24:27]
    ds_read_b64_tr_b16 v[94:95], v18 offset:41472
    s_waitcnt lgkmcnt(8)
    v_mfma_f32_16x16x32_bf16 v[36:39], v[76:79], v[220:223], v[36:39]
    s_barrier
    ds_read_b64_tr_b16 v[72:73], v9 offset:0
    v_mfma_f32_16x16x32_bf16 v[28:31], v[76:79], v[216:219], v[28:31]
    ds_read_b64_tr_b16 v[74:75], v9 offset:512
    s_waitcnt lgkmcnt(8)
    v_mfma_f32_16x16x32_bf16 v[48:51], v[80:83], v[220:223], v[48:51]
    ds_read_b64_tr_b16 v[76:77], v19 offset:0
    v_mfma_f32_16x16x32_bf16 v[40:43], v[80:83], v[216:219], v[40:43]
    ds_read_b64_tr_b16 v[78:79], v19 offset:512
    s_waitcnt lgkmcnt(8)
    v_mfma_f32_16x16x32_bf16 v[52:55], v[84:87], v[220:223], v[52:55]
    ds_read_b64_tr_b16 v[80:81], v9 offset:2048
    v_mfma_f32_16x16x32_bf16 v[44:47], v[84:87], v[216:219], v[44:47]
    ds_read_b64_tr_b16 v[82:83], v9 offset:2560
    s_waitcnt lgkmcnt(8)
    v_mfma_f32_16x16x32_bf16 v[64:67], v[88:91], v[220:223], v[64:67]
    ds_read_b64_tr_b16 v[84:85], v19 offset:2048
    v_mfma_f32_16x16x32_bf16 v[56:59], v[88:91], v[216:219], v[56:59]
    ds_read_b64_tr_b16 v[86:87], v19 offset:2560
    s_waitcnt lgkmcnt(8)
    v_mfma_f32_16x16x32_bf16 v[68:71], v[92:95], v[220:223], v[68:71]
    ds_read_b64_tr_b16 v[88:89], v9 offset:4096
    v_mfma_f32_16x16x32_bf16 v[60:63], v[92:95], v[216:219], v[60:63]
    ds_read_b64_tr_b16 v[90:91], v9 offset:4608
    s_waitcnt lgkmcnt(8)
    v_mfma_f32_16x16x32_bf16 v[32:35], v[72:75], v[228:231], v[32:35]
    ds_read_b64_tr_b16 v[92:93], v19 offset:4096
    v_mfma_f32_16x16x32_bf16 v[24:27], v[72:75], v[224:227], v[24:27]
    ds_read_b64_tr_b16 v[94:95], v19 offset:4608
    s_waitcnt lgkmcnt(8)
    v_mfma_f32_16x16x32_bf16 v[36:39], v[76:79], v[228:231], v[36:39]
    ds_read_b64_tr_b16 v[72:73], v9 offset:12288
    v_mfma_f32_16x16x32_bf16 v[28:31], v[76:79], v[224:227], v[28:31]
    ds_read_b64_tr_b16 v[74:75], v9 offset:12800
    s_waitcnt lgkmcnt(8)
    v_mfma_f32_16x16x32_bf16 v[48:51], v[80:83], v[228:231], v[48:51]
    ds_read_b64_tr_b16 v[76:77], v19 offset:12288
    v_mfma_f32_16x16x32_bf16 v[40:43], v[80:83], v[224:227], v[40:43]
    ds_read_b64_tr_b16 v[78:79], v19 offset:12800
    s_waitcnt lgkmcnt(8)
    v_mfma_f32_16x16x32_bf16 v[52:55], v[84:87], v[228:231], v[52:55]
    ds_read_b64_tr_b16 v[80:81], v9 offset:14336
    v_mfma_f32_16x16x32_bf16 v[44:47], v[84:87], v[224:227], v[44:47]
    ds_read_b64_tr_b16 v[82:83], v9 offset:14848
    s_waitcnt lgkmcnt(8)
    v_mfma_f32_16x16x32_bf16 v[64:67], v[88:91], v[228:231], v[64:67]
    ds_read_b64_tr_b16 v[84:85], v19 offset:14336
    v_mfma_f32_16x16x32_bf16 v[56:59], v[88:91], v[224:227], v[56:59]
    ds_read_b64_tr_b16 v[86:87], v19 offset:14848
    s_waitcnt lgkmcnt(8)
    v_mfma_f32_16x16x32_bf16 v[68:71], v[92:95], v[228:231], v[68:71]
    ds_read_b64_tr_b16 v[88:89], v9 offset:16384
    v_mfma_f32_16x16x32_bf16 v[60:63], v[92:95], v[224:227], v[60:63]
    ds_read_b64_tr_b16 v[90:91], v9 offset:16896
    s_waitcnt lgkmcnt(8)
    v_mfma_f32_16x16x32_bf16 v[32:35], v[72:75], v[236:239], v[32:35]
    ds_read_b64_tr_b16 v[92:93], v19 offset:16384
    v_and_b32 v7, 27, v0
    v_mfma_f32_16x16x32_bf16 v[24:27], v[72:75], v[232:235], v[24:27]
    ds_read_b64_tr_b16 v[94:95], v19 offset:16896
    v_cmp_eq_u32 vcc, 16, v7
    s_waitcnt lgkmcnt(8)
    v_mfma_f32_16x16x32_bf16 v[36:39], v[76:79], v[236:239], v[36:39]
    s_barrier
    ds_read_b64_tr_b16 v[72:73], v9 offset:24576
    v_mov_b32 v7, 0x3f803f80
    v_mfma_f32_16x16x32_bf16 v[28:31], v[76:79], v[232:235], v[28:31]
    ds_read_b64_tr_b16 v[74:75], v9 offset:25088
    v_cndmask_b32 v7, 0, v7, vcc
    s_waitcnt lgkmcnt(8)
    v_mfma_f32_16x16x32_bf16 v[48:51], v[80:83], v[236:239], v[48:51]
    ds_read_b64_tr_b16 v[76:77], v19 offset:24576
    v_mov_b32 v196, v7
    v_mfma_f32_16x16x32_bf16 v[40:43], v[80:83], v[232:235], v[40:43]
    ds_read_b64_tr_b16 v[78:79], v19 offset:25088
    v_mov_b32 v197, v7
    s_waitcnt lgkmcnt(8)
    v_mfma_f32_16x16x32_bf16 v[52:55], v[84:87], v[236:239], v[52:55]
    ds_read_b64_tr_b16 v[80:81], v9 offset:26624
    v_mov_b32 v198, v7
    v_mfma_f32_16x16x32_bf16 v[44:47], v[84:87], v[232:235], v[44:47]
    ds_read_b64_tr_b16 v[82:83], v9 offset:27136
    v_mov_b32 v199, v7
    s_waitcnt lgkmcnt(8)
    v_mfma_f32_16x16x32_bf16 v[64:67], v[88:91], v[236:239], v[64:67]
    ds_read_b64_tr_b16 v[84:85], v19 offset:26624
    v_mov_b32 v200, v7
    v_mfma_f32_16x16x32_bf16 v[56:59], v[88:91], v[232:235], v[56:59]
    ds_read_b64_tr_b16 v[86:87], v19 offset:27136
    v_mov_b32 v201, v7
    s_waitcnt lgkmcnt(8)
    v_mfma_f32_16x16x32_bf16 v[68:71], v[92:95], v[236:239], v[68:71]
    ds_read_b64_tr_b16 v[88:89], v9 offset:28672
    v_mov_b32 v202, v7
    v_mfma_f32_16x16x32_bf16 v[60:63], v[92:95], v[232:235], v[60:63]
    ds_read_b64_tr_b16 v[90:91], v9 offset:29184
    v_mov_b32 v203, v7
    s_waitcnt lgkmcnt(8)
    v_mfma_f32_16x16x32_bf16 v[32:35], v[72:75], v[244:247], v[32:35]
    ds_read_b64_tr_b16 v[92:93], v19 offset:28672
    v_mov_b32 v208, v7
    v_mfma_f32_16x16x32_bf16 v[24:27], v[72:75], v[240:243], v[24:27]
    ds_read_b64_tr_b16 v[94:95], v19 offset:29184
    v_mov_b32 v209, v7
    s_waitcnt lgkmcnt(8)
    v_mfma_f32_16x16x32_bf16 v[36:39], v[76:79], v[244:247], v[36:39]
    ds_read_b64_tr_b16 v[72:73], v9 offset:36864
    v_mov_b32 v210, v7
    v_mfma_f32_16x16x32_bf16 v[28:31], v[76:79], v[240:243], v[28:31]
    ds_read_b64_tr_b16 v[74:75], v9 offset:37376
    v_mov_b32 v211, v7
    s_waitcnt lgkmcnt(8)
    v_mfma_f32_16x16x32_bf16 v[48:51], v[80:83], v[244:247], v[48:51]
    ds_read_b64_tr_b16 v[76:77], v19 offset:36864
    v_mov_b32 v212, v7
    v_mfma_f32_16x16x32_bf16 v[40:43], v[80:83], v[240:243], v[40:43]
    ds_read_b64_tr_b16 v[78:79], v19 offset:37376
    v_mov_b32 v213, v7
    s_waitcnt lgkmcnt(8)
    v_mfma_f32_16x16x32_bf16 v[52:55], v[84:87], v[244:247], v[52:55]
    ds_read_b64_tr_b16 v[80:81], v9 offset:38912
    v_mov_b32 v214, v7
    v_mfma_f32_16x16x32_bf16 v[44:47], v[84:87], v[240:243], v[44:47]
    ds_read_b64_tr_b16 v[82:83], v9 offset:39424
    v_mov_b32 v215, v7
    s_waitcnt lgkmcnt(8)
    v_mfma_f32_16x16x32_bf16 v[64:67], v[88:91], v[244:247], v[64:67]
    ds_read_b64_tr_b16 v[84:85], v19 offset:38912
    v_mov_b32 v220, v7
    v_mfma_f32_16x16x32_bf16 v[56:59], v[88:91], v[240:243], v[56:59]
    ds_read_b64_tr_b16 v[86:87], v19 offset:39424
    v_mov_b32 v221, v7
    s_waitcnt lgkmcnt(8)
    v_mfma_f32_16x16x32_bf16 v[68:71], v[92:95], v[244:247], v[68:71]
    ds_read_b64_tr_b16 v[88:89], v9 offset:40960
    v_mov_b32 v222, v7
    v_mfma_f32_16x16x32_bf16 v[60:63], v[92:95], v[240:243], v[60:63]
    ds_read_b64_tr_b16 v[90:91], v9 offset:41472
    v_mov_b32 v223, v7
    s_waitcnt lgkmcnt(8)
    v_mfma_f32_16x16x32_bf16 v[32:35], v[72:75], v[252:255], v[32:35]
    ds_read_b64_tr_b16 v[92:93], v19 offset:40960
    v_mov_b32 v224, v7
    v_mfma_f32_16x16x32_bf16 v[24:27], v[72:75], v[248:251], v[24:27]
    ds_read_b64_tr_b16 v[94:95], v19 offset:41472
    v_mov_b32 v225, v7
    s_waitcnt lgkmcnt(8)
    v_mfma_f32_16x16x32_bf16 v[36:39], v[76:79], v[252:255], v[36:39]
    v_mov_b32 v226, v7
    v_mov_b32 v227, v7
    v_mfma_f32_16x16x32_bf16 v[28:31], v[76:79], v[248:251], v[28:31]
    s_waitcnt lgkmcnt(6)
    v_mfma_f32_16x16x32_bf16 v[48:51], v[80:83], v[252:255], v[48:51]
    v_mfma_f32_16x16x32_bf16 v[40:43], v[80:83], v[248:251], v[40:43]
    s_waitcnt lgkmcnt(4)
    v_mfma_f32_16x16x32_bf16 v[52:55], v[84:87], v[252:255], v[52:55]
    v_mfma_f32_16x16x32_bf16 v[44:47], v[84:87], v[248:251], v[44:47]
    s_waitcnt lgkmcnt(2)
    v_mfma_f32_16x16x32_bf16 v[64:67], v[88:91], v[252:255], v[64:67]
    v_mfma_f32_16x16x32_bf16 v[56:59], v[88:91], v[248:251], v[56:59]
    s_waitcnt lgkmcnt(0)
    v_mfma_f32_16x16x32_bf16 v[68:71], v[92:95], v[252:255], v[68:71]
    v_mfma_f32_16x16x32_bf16 v[60:63], v[92:95], v[248:251], v[60:63]
    s_barrier
    s_setprio 2
    v_max_f32 v24, 0, v24
    v_max_f32 v25, 0, v25
    v_max_f32 v26, 0, v26
    v_max_f32 v27, 0, v27
    v_max_f32 v28, 0, v28
    v_max_f32 v29, 0, v29
    v_max_f32 v30, 0, v30
    v_max_f32 v31, 0, v31
    v_max_f32 v32, 0, v32
    v_max_f32 v33, 0, v33
    v_max_f32 v34, 0, v34
    v_max_f32 v35, 0, v35
    v_max_f32 v36, 0, v36
    v_max_f32 v37, 0, v37
    v_max_f32 v38, 0, v38
    v_max_f32 v39, 0, v39
    v_mul_f32 v24, v24, v24
    v_mul_f32 v25, v25, v25
    v_mul_f32 v26, v26, v26
    v_mul_f32 v27, v27, v27
    v_mul_f32 v28, v28, v28
    v_mul_f32 v29, v29, v29
    v_mul_f32 v30, v30, v30
    v_mul_f32 v31, v31, v31
    v_mul_f32 v32, v32, v32
    v_mul_f32 v33, v33, v33
    v_mul_f32 v34, v34, v34
    v_mul_f32 v35, v35, v35
    v_mul_f32 v36, v36, v36
    v_mul_f32 v37, v37, v37
    v_mul_f32 v38, v38, v38
    v_mul_f32 v39, v39, v39
    v_cvt_pk_bf16_f32 v96, v24, v25
    v_cvt_pk_bf16_f32 v97, v26, v27
    v_cvt_pk_bf16_f32 v98, v28, v29
    v_cvt_pk_bf16_f32 v99, v30, v31
    v_cvt_pk_bf16_f32 v100, v32, v33
    v_cvt_pk_bf16_f32 v101, v34, v35
    v_cvt_pk_bf16_f32 v102, v36, v37
    v_cvt_pk_bf16_f32 v103, v38, v39
    v_max_f32 v40, 0, v40
    v_max_f32 v41, 0, v41
    v_max_f32 v42, 0, v42
    v_max_f32 v43, 0, v43
    v_max_f32 v44, 0, v44
    v_max_f32 v45, 0, v45
    v_max_f32 v46, 0, v46
    v_max_f32 v47, 0, v47
    v_max_f32 v48, 0, v48
    v_max_f32 v49, 0, v49
    v_max_f32 v50, 0, v50
    v_max_f32 v51, 0, v51
    v_max_f32 v52, 0, v52
    v_max_f32 v53, 0, v53
    v_max_f32 v54, 0, v54
    v_max_f32 v55, 0, v55
    v_mul_f32 v40, v40, v40
    v_mul_f32 v41, v41, v41
    v_mul_f32 v42, v42, v42
    v_mul_f32 v43, v43, v43
    v_mul_f32 v44, v44, v44
    v_mul_f32 v45, v45, v45
    v_mul_f32 v46, v46, v46
    v_mul_f32 v47, v47, v47
    v_mul_f32 v48, v48, v48
    v_mul_f32 v49, v49, v49
    v_mul_f32 v50, v50, v50
    v_mul_f32 v51, v51, v51
    v_mul_f32 v52, v52, v52
    v_mul_f32 v53, v53, v53
    v_mul_f32 v54, v54, v54
    v_mul_f32 v55, v55, v55
    v_cvt_pk_bf16_f32 v104, v40, v41
    v_cvt_pk_bf16_f32 v105, v42, v43
    v_cvt_pk_bf16_f32 v106, v44, v45
    v_cvt_pk_bf16_f32 v107, v46, v47
    v_cvt_pk_bf16_f32 v108, v48, v49
    v_cvt_pk_bf16_f32 v109, v50, v51
    v_cvt_pk_bf16_f32 v110, v52, v53
    v_cvt_pk_bf16_f32 v111, v54, v55
    v_and_b32 v252, 0x230, v1
    v_and_b32 v253, 0x180, v1
    v_lshrrev_b32 v253, 1, v253
    v_and_b32 v254, 64, v1
    v_lshlrev_b32 v254, 2, v254
    v_or3_b32 v252, v252, v253, v254
    buffer_load_dwordx4 v[8:11], v1, s[56:59], s92 offen offset:0 sc1
    buffer_load_dwordx4 v[192:195], v252, s[56:59], s82 offen offset:0 sc1
    s_mov_b64 exec, s[70:71]
    buffer_load_dwordx4 v[196:199], v2, s[56:59], s82 offen offset:1024 sc1
    buffer_load_dwordx4 v[200:203], v2, s[56:59], s82 offen offset:1536 sc1
    s_mov_b64 exec, -1
    s_add_u32 s82, s82, 2048
    buffer_load_dwordx4 v[12:15], v1, s[56:59], s93 offen offset:0 sc1
    buffer_load_dwordx4 v[16:19], v1, s[56:59], s94 offen offset:0 sc1
    buffer_load_dwordx4 v[20:23], v1, s[56:59], s95 offen offset:0 sc1
    buffer_load_dwordx4 v[204:207], v252, s[56:59], s82 offen offset:0 sc1
    s_mov_b64 exec, s[70:71]
    buffer_load_dwordx4 v[208:211], v2, s[56:59], s82 offen offset:1024 sc1
    buffer_load_dwordx4 v[212:215], v2, s[56:59], s82 offen offset:1536 sc1
    s_mov_b64 exec, -1
    s_add_u32 s82, s82, 2048
    buffer_load_dwordx4 v[216:219], v252, s[56:59], s82 offen offset:0 sc1
    s_mov_b64 exec, s[70:71]
    buffer_load_dwordx4 v[220:223], v2, s[56:59], s82 offen offset:1024 sc1
    buffer_load_dwordx4 v[224:227], v2, s[56:59], s82 offen offset:1536 sc1
    s_mov_b64 exec, -1
    s_add_u32 s82, s82, 2048
    v_mov_b32 v76, v7
    v_mov_b32 v77, v7
    v_mov_b32 v78, v7
    v_mov_b32 v79, v7
    v_mov_b32 v80, v7
    v_mov_b32 v81, v7
    v_mov_b32 v82, v7
    v_mov_b32 v83, v7
    v_mov_b32 v88, v7
    v_mov_b32 v89, v7
    v_mov_b32 v90, v7
    v_mov_b32 v91, v7
    v_mov_b32 v92, v7
    v_mov_b32 v93, v7
    v_mov_b32 v94, v7
    v_mov_b32 v95, v7
    buffer_store_dwordx4 v[96:99], v127, s[56:59], s78 offen offset:0 sc1
    buffer_store_dwordx4 v[100:103], v127, s[56:59], s78 offen offset:256 sc1
    v_max_f32 v56, 0, v56
    v_max_f32 v57, 0, v57
    v_max_f32 v58, 0, v58
    v_max_f32 v59, 0, v59
    v_max_f32 v60, 0, v60
    v_max_f32 v61, 0, v61
    v_max_f32 v62, 0, v62
    v_max_f32 v63, 0, v63
    v_max_f32 v64, 0, v64
    v_max_f32 v65, 0, v65
    v_max_f32 v66, 0, v66
    v_max_f32 v67, 0, v67
    v_max_f32 v68, 0, v68
    v_max_f32 v69, 0, v69
    v_max_f32 v70, 0, v70
    v_max_f32 v71, 0, v71
    v_mul_f32 v56, v56, v56
    v_mul_f32 v57, v57, v57
    v_mul_f32 v58, v58, v58
    v_mul_f32 v59, v59, v59
    v_mul_f32 v60, v60, v60
    v_mul_f32 v61, v61, v61
    v_mul_f32 v62, v62, v62
    v_mul_f32 v63, v63, v63
    v_mul_f32 v64, v64, v64
    v_mul_f32 v65, v65, v65
    v_mul_f32 v66, v66, v66
    v_mul_f32 v67, v67, v67
    v_mul_f32 v68, v68, v68
    v_mul_f32 v69, v69, v69
    v_mul_f32 v70, v70, v70
    v_mul_f32 v71, v71, v71
    v_cvt_pk_bf16_f32 v112, v56, v57
    v_cvt_pk_bf16_f32 v113, v58, v59
    v_cvt_pk_bf16_f32 v114, v60, v61
    v_cvt_pk_bf16_f32 v115, v62, v63
    v_cvt_pk_bf16_f32 v116, v64, v65
    v_cvt_pk_bf16_f32 v117, v66, v67
    v_cvt_pk_bf16_f32 v118, v68, v69
    v_cvt_pk_bf16_f32 v119, v70, v71
    s_waitcnt vmcnt(8)
    v_mfma_f32_32x32x16_bf16 v[24:39], v[192:195], v[8:11], 0
    s_nop 11
    v_exp_f32 v24, v24
    v_exp_f32 v25, v25
    v_exp_f32 v26, v26
    v_exp_f32 v27, v27
    v_exp_f32 v28, v28
    v_mfma_f32_32x32x16_bf16 v[40:55], v[192:195], v[12:15], 0
    v_exp_f32 v29, v29
    v_exp_f32 v30, v30
    v_exp_f32 v31, v31
    v_exp_f32 v32, v32
    v_exp_f32 v33, v33
    s_add_u32 s78, s78, 0x40000
    buffer_store_dwordx4 v[104:107], v127, s[56:59], s78 offen offset:0 sc1
    v_exp_f32 v34, v34
    v_smfmac_f32_32x32x32_bf16 v[128:143], v[196:199], v[24:31], v3
    v_exp_f32 v35, v35
    v_exp_f32 v36, v36
    v_exp_f32 v37, v37
    v_exp_f32 v38, v38
    v_exp_f32 v39, v39
    v_exp_f32 v40, v40
    v_exp_f32 v41, v41
    v_smfmac_f32_32x32x32_bf16 v[128:143], v[200:203], v[32:39], v3
    v_exp_f32 v42, v42
    v_exp_f32 v43, v43
    v_exp_f32 v44, v44
    v_mfma_f32_32x32x16_bf16 v[24:39], v[192:195], v[16:19], 0
    v_exp_f32 v45, v45
    v_exp_f32 v46, v46
    v_exp_f32 v47, v47
    v_exp_f32 v48, v48
    v_exp_f32 v49, v49
    v_exp_f32 v50, v50
    v_smfmac_f32_32x32x32_bf16 v[144:159], v[196:199], v[40:47], v3
    v_exp_f32 v51, v51
    v_exp_f32 v52, v52
    v_exp_f32 v53, v53
    v_exp_f32 v54, v54
    v_exp_f32 v55, v55
    v_exp_f32 v24, v24
    v_exp_f32 v25, v25
    v_smfmac_f32_32x32x32_bf16 v[144:159], v[200:203], v[48:55], v3
    v_exp_f32 v26, v26
    v_exp_f32 v27, v27
    v_exp_f32 v28, v28
    v_mfma_f32_32x32x16_bf16 v[40:55], v[192:195], v[20:23], 0
    v_exp_f32 v29, v29
    v_exp_f32 v30, v30
    v_exp_f32 v31, v31
    v_exp_f32 v32, v32
    v_exp_f32 v33, v33
    buffer_store_dwordx4 v[108:111], v127, s[56:59], s78 offen offset:256 sc1
    v_exp_f32 v34, v34
    v_smfmac_f32_32x32x32_bf16 v[160:175], v[196:199], v[24:31], v3
    v_exp_f32 v35, v35
    v_exp_f32 v36, v36
    v_exp_f32 v37, v37
    v_exp_f32 v38, v38
    v_exp_f32 v39, v39
    v_exp_f32 v40, v40
    v_exp_f32 v41, v41
    v_smfmac_f32_32x32x32_bf16 v[160:175], v[200:203], v[32:39], v3
    v_exp_f32 v42, v42
    v_exp_f32 v43, v43
    v_exp_f32 v44, v44
    s_waitcnt vmcnt(7)
    v_mfma_f32_32x32x16_bf16 v[24:39], v[204:207], v[8:11], 0
    v_exp_f32 v45, v45
    v_exp_f32 v46, v46
    v_exp_f32 v47, v47
    v_exp_f32 v48, v48
    v_exp_f32 v49, v49
    v_exp_f32 v50, v50
    v_smfmac_f32_32x32x32_bf16 v[176:191], v[196:199], v[40:47], v3
    v_exp_f32 v51, v51
    v_exp_f32 v52, v52
    v_exp_f32 v53, v53
    v_exp_f32 v54, v54
    v_exp_f32 v55, v55
    v_exp_f32 v24, v24
    v_exp_f32 v25, v25
    v_smfmac_f32_32x32x32_bf16 v[176:191], v[200:203], v[48:55], v3
    v_exp_f32 v26, v26
    v_exp_f32 v27, v27
    v_exp_f32 v28, v28
    buffer_load_dwordx4 v[192:195], v252, s[56:59], s82 offen offset:0 sc1
    s_mov_b64 exec, s[70:71]
    buffer_load_dwordx4 v[196:199], v2, s[56:59], s82 offen offset:1024 sc1
    buffer_load_dwordx4 v[200:203], v2, s[56:59], s82 offen offset:1536 sc1
    s_mov_b64 exec, -1
    s_add_u32 s82, s82, 2048
    v_mfma_f32_32x32x16_bf16 v[40:55], v[204:207], v[12:15], 0
    v_exp_f32 v29, v29
    v_exp_f32 v30, v30
    v_exp_f32 v31, v31
    v_exp_f32 v32, v32
    v_exp_f32 v33, v33
    buffer_store_dwordx4 v[112:115], v127, s[56:59], s88 offen offset:0 sc1
    v_exp_f32 v34, v34
    v_smfmac_f32_32x32x32_bf16 v[128:143], v[208:211], v[24:31], v3
    v_exp_f32 v35, v35
    v_exp_f32 v36, v36
    v_exp_f32 v37, v37
    v_exp_f32 v38, v38
    v_exp_f32 v39, v39
    v_exp_f32 v40, v40
    v_exp_f32 v41, v41
    v_smfmac_f32_32x32x32_bf16 v[128:143], v[212:215], v[32:39], v3
    v_exp_f32 v42, v42
    v_exp_f32 v43, v43
    v_exp_f32 v44, v44
    v_mfma_f32_32x32x16_bf16 v[24:39], v[204:207], v[16:19], 0
    v_exp_f32 v45, v45
    v_exp_f32 v46, v46
    v_exp_f32 v47, v47
    v_exp_f32 v48, v48
    v_exp_f32 v49, v49
    v_exp_f32 v50, v50
    v_smfmac_f32_32x32x32_bf16 v[144:159], v[208:211], v[40:47], v3
    v_exp_f32 v51, v51
    v_exp_f32 v52, v52
    v_exp_f32 v53, v53
    v_exp_f32 v54, v54
    v_exp_f32 v55, v55
    v_exp_f32 v24, v24
    v_exp_f32 v25, v25
    v_smfmac_f32_32x32x32_bf16 v[144:159], v[212:215], v[48:55], v3
    v_exp_f32 v26, v26
    v_exp_f32 v27, v27
    v_exp_f32 v28, v28
    v_mfma_f32_32x32x16_bf16 v[40:55], v[204:207], v[20:23], 0
    v_exp_f32 v29, v29
    v_exp_f32 v30, v30
    v_exp_f32 v31, v31
    v_exp_f32 v32, v32
    v_exp_f32 v33, v33
    buffer_store_dwordx4 v[116:119], v127, s[56:59], s88 offen offset:256 sc1
    v_exp_f32 v34, v34
    v_smfmac_f32_32x32x32_bf16 v[160:175], v[208:211], v[24:31], v3
    v_exp_f32 v35, v35
    v_exp_f32 v36, v36
    v_exp_f32 v37, v37
    v_exp_f32 v38, v38
    v_exp_f32 v39, v39
    v_exp_f32 v40, v40
    v_exp_f32 v41, v41
    v_smfmac_f32_32x32x32_bf16 v[160:175], v[212:215], v[32:39], v3
    v_exp_f32 v42, v42
    v_exp_f32 v43, v43
    v_exp_f32 v44, v44
    s_waitcnt vmcnt(9)
    v_mfma_f32_32x32x16_bf16 v[24:39], v[216:219], v[8:11], 0
    v_exp_f32 v45, v45
    v_exp_f32 v46, v46
    v_exp_f32 v47, v47
    v_exp_f32 v48, v48
    v_exp_f32 v49, v49
    v_exp_f32 v50, v50
    v_smfmac_f32_32x32x32_bf16 v[176:191], v[208:211], v[40:47], v3
    v_exp_f32 v51, v51
    v_exp_f32 v52, v52
    v_exp_f32 v53, v53
    v_exp_f32 v54, v54
    v_exp_f32 v55, v55
    v_exp_f32 v24, v24
    v_exp_f32 v25, v25
    v_smfmac_f32_32x32x32_bf16 v[176:191], v[212:215], v[48:55], v3
    v_exp_f32 v26, v26
    v_exp_f32 v27, v27
    v_exp_f32 v28, v28
    buffer_load_dwordx4 v[204:207], v252, s[56:59], s82 offen offset:0 sc1
    s_mov_b64 exec, s[70:71]
    buffer_load_dwordx4 v[208:211], v2, s[56:59], s82 offen offset:1024 sc1
    buffer_load_dwordx4 v[212:215], v2, s[56:59], s82 offen offset:1536 sc1
    s_mov_b64 exec, -1
    s_add_u32 s82, s82, 2048
    v_mfma_f32_32x32x16_bf16 v[40:55], v[216:219], v[12:15], 0
    v_exp_f32 v29, v29
    v_exp_f32 v30, v30
    v_exp_f32 v31, v31
    v_exp_f32 v32, v32
    v_exp_f32 v33, v33
    v_exp_f32 v34, v34
    v_smfmac_f32_32x32x32_bf16 v[128:143], v[220:223], v[24:31], v3
    v_exp_f32 v35, v35
    v_exp_f32 v36, v36
    v_exp_f32 v37, v37
    v_exp_f32 v38, v38
    v_exp_f32 v39, v39
    v_exp_f32 v40, v40
    v_exp_f32 v41, v41
    v_smfmac_f32_32x32x32_bf16 v[128:143], v[224:227], v[32:39], v3
    v_exp_f32 v42, v42
    v_exp_f32 v43, v43
    v_exp_f32 v44, v44
    buffer_load_dwordx4 v[72:75], v252, s[56:59], s82 offen offset:0 sc1
    s_mov_b64 exec, s[70:71]
    buffer_load_dwordx4 v[76:79], v2, s[56:59], s82 offen offset:1024 sc1
    buffer_load_dwordx4 v[80:83], v2, s[56:59], s82 offen offset:1536 sc1
    s_mov_b64 exec, -1
    s_add_u32 s82, s82, 2048
    v_mfma_f32_32x32x16_bf16 v[24:39], v[216:219], v[16:19], 0
    v_exp_f32 v45, v45
    v_exp_f32 v46, v46
    v_exp_f32 v47, v47
    v_exp_f32 v48, v48
    v_exp_f32 v49, v49
    v_exp_f32 v50, v50
    v_smfmac_f32_32x32x32_bf16 v[144:159], v[220:223], v[40:47], v3
    v_exp_f32 v51, v51
    v_exp_f32 v52, v52
    v_exp_f32 v53, v53
    v_exp_f32 v54, v54
    v_exp_f32 v55, v55
    v_exp_f32 v24, v24
    v_exp_f32 v25, v25
    v_smfmac_f32_32x32x32_bf16 v[144:159], v[224:227], v[48:55], v3
    v_exp_f32 v26, v26
    v_exp_f32 v27, v27
    v_exp_f32 v28, v28
    buffer_load_dwordx4 v[84:87], v252, s[56:59], s82 offen offset:0 sc1
    s_mov_b64 exec, s[70:71]
    buffer_load_dwordx4 v[88:91], v2, s[56:59], s82 offen offset:1024 sc1
    buffer_load_dwordx4 v[92:95], v2, s[56:59], s82 offen offset:1536 sc1
    s_mov_b64 exec, -1
    s_add_u32 s82, s82, 2048
    v_mfma_f32_32x32x16_bf16 v[40:55], v[216:219], v[20:23], 0
    v_exp_f32 v29, v29
    v_exp_f32 v30, v30
    v_exp_f32 v31, v31
    v_exp_f32 v32, v32
    v_exp_f32 v33, v33
    v_exp_f32 v34, v34
    v_smfmac_f32_32x32x32_bf16 v[160:175], v[220:223], v[24:31], v3
    v_exp_f32 v35, v35
    v_exp_f32 v36, v36
    v_exp_f32 v37, v37
    v_exp_f32 v38, v38
    v_exp_f32 v39, v39
    v_exp_f32 v40, v40
    v_exp_f32 v41, v41
    v_smfmac_f32_32x32x32_bf16 v[160:175], v[224:227], v[32:39], v3
    v_exp_f32 v42, v42
    v_exp_f32 v43, v43
    v_exp_f32 v44, v44
    s_waitcnt vmcnt(11)
    v_mfma_f32_32x32x16_bf16 v[24:39], v[192:195], v[8:11], 0
    v_exp_f32 v45, v45
    v_exp_f32 v46, v46
    v_exp_f32 v47, v47
    v_exp_f32 v48, v48
    v_exp_f32 v49, v49
    v_exp_f32 v50, v50
    v_smfmac_f32_32x32x32_bf16 v[176:191], v[220:223], v[40:47], v3
    v_exp_f32 v51, v51
    v_exp_f32 v52, v52
    s_waitcnt vmcnt(9)
    v_mov_b32 v7, s68
    s_mov_b64 exec, 1
    buffer_store_dword v7, v1, s[56:59], s80 offen offset:0 sc0 sc1
    s_mov_b64 exec, -1
    v_exp_f32 v53, v53
    v_exp_f32 v54, v54
    v_exp_f32 v55, v55
    v_exp_f32 v24, v24
    v_exp_f32 v25, v25
    v_smfmac_f32_32x32x32_bf16 v[176:191], v[224:227], v[48:55], v3
    v_exp_f32 v26, v26
    v_exp_f32 v27, v27
    v_exp_f32 v28, v28
    buffer_load_dwordx4 v[216:219], v252, s[56:59], s82 offen offset:0 sc1
    s_mov_b64 exec, s[70:71]
    buffer_load_dwordx4 v[220:223], v2, s[56:59], s82 offen offset:1024 sc1
    buffer_load_dwordx4 v[224:227], v2, s[56:59], s82 offen offset:1536 sc1
    s_mov_b64 exec, -1
    s_add_u32 s82, s82, 2048
    v_mfma_f32_32x32x16_bf16 v[40:55], v[192:195], v[12:15], 0
    v_exp_f32 v29, v29
    v_exp_f32 v30, v30
    v_exp_f32 v31, v31
    v_exp_f32 v32, v32
    v_exp_f32 v33, v33
    v_exp_f32 v34, v34
    v_smfmac_f32_32x32x32_bf16 v[128:143], v[196:199], v[24:31], v3
    v_exp_f32 v35, v35
    v_exp_f32 v36, v36
    v_exp_f32 v37, v37
    v_exp_f32 v38, v38
    v_exp_f32 v39, v39
    v_exp_f32 v40, v40
    v_exp_f32 v41, v41
    v_smfmac_f32_32x32x32_bf16 v[128:143], v[200:203], v[32:39], v3
    v_exp_f32 v42, v42
    v_exp_f32 v43, v43
    v_exp_f32 v44, v44
    v_mfma_f32_32x32x16_bf16 v[24:39], v[192:195], v[16:19], 0
    v_exp_f32 v45, v45
    v_exp_f32 v46, v46
    v_exp_f32 v47, v47
    v_exp_f32 v48, v48
    v_exp_f32 v49, v49
    buffer_load_dword v255, v125, s[44:47], s100 offen offset:0
    buffer_load_dword v255, v125, s[32:35], s100 offen offset:0
    v_exp_f32 v50, v50
    v_smfmac_f32_32x32x32_bf16 v[144:159], v[196:199], v[40:47], v3
    v_exp_f32 v51, v51
    v_exp_f32 v52, v52
    v_exp_f32 v53, v53
    v_exp_f32 v54, v54
    v_exp_f32 v55, v55
    v_exp_f32 v24, v24
    v_exp_f32 v25, v25
    v_smfmac_f32_32x32x32_bf16 v[144:159], v[200:203], v[48:55], v3
    v_exp_f32 v26, v26
    v_exp_f32 v27, v27
    v_exp_f32 v28, v28
    v_mfma_f32_32x32x16_bf16 v[40:55], v[192:195], v[20:23], 0
    v_exp_f32 v29, v29
    v_exp_f32 v30, v30
    v_exp_f32 v31, v31
    v_exp_f32 v32, v32
    v_exp_f32 v33, v33
    v_exp_f32 v34, v34
    v_smfmac_f32_32x32x32_bf16 v[160:175], v[196:199], v[24:31], v3
    v_exp_f32 v35, v35
    v_exp_f32 v36, v36
    v_exp_f32 v37, v37
    v_exp_f32 v38, v38
    v_exp_f32 v39, v39
    v_exp_f32 v40, v40
    v_exp_f32 v41, v41
    v_smfmac_f32_32x32x32_bf16 v[160:175], v[200:203], v[32:39], v3
    v_exp_f32 v42, v42
    v_exp_f32 v43, v43
    v_exp_f32 v44, v44
    s_waitcnt vmcnt(12)
    v_mfma_f32_32x32x16_bf16 v[24:39], v[204:207], v[8:11], 0
    v_exp_f32 v45, v45
    v_exp_f32 v46, v46
    v_exp_f32 v47, v47
    v_exp_f32 v48, v48
    v_exp_f32 v49, v49
    v_exp_f32 v50, v50
    v_smfmac_f32_32x32x32_bf16 v[176:191], v[196:199], v[40:47], v3
    v_exp_f32 v51, v51
    v_exp_f32 v52, v52
    v_exp_f32 v53, v53
    v_exp_f32 v54, v54
    v_exp_f32 v55, v55
    v_exp_f32 v24, v24
    v_exp_f32 v25, v25
    v_smfmac_f32_32x32x32_bf16 v[176:191], v[200:203], v[48:55], v3
    v_exp_f32 v26, v26
    v_exp_f32 v27, v27
    v_exp_f32 v28, v28
    buffer_load_dwordx4 v[192:195], v252, s[56:59], s82 offen offset:0 sc1
    s_mov_b64 exec, s[70:71]
    buffer_load_dwordx4 v[196:199], v2, s[56:59], s82 offen offset:1024 sc1
    buffer_load_dwordx4 v[200:203], v2, s[56:59], s82 offen offset:1536 sc1
    s_mov_b64 exec, -1
    s_add_u32 s82, s82, 2048
    v_mfma_f32_32x32x16_bf16 v[40:55], v[204:207], v[12:15], 0
    v_exp_f32 v29, v29
    v_exp_f32 v30, v30
    v_exp_f32 v31, v31
    v_exp_f32 v32, v32
    v_exp_f32 v33, v33
    v_exp_f32 v34, v34
    v_smfmac_f32_32x32x32_bf16 v[128:143], v[208:211], v[24:31], v3
    v_exp_f32 v35, v35
    v_exp_f32 v36, v36
    v_exp_f32 v37, v37
    v_exp_f32 v38, v38
    v_exp_f32 v39, v39
    v_exp_f32 v40, v40
    v_exp_f32 v41, v41
    v_smfmac_f32_32x32x32_bf16 v[128:143], v[212:215], v[32:39], v3
    v_exp_f32 v42, v42
    v_exp_f32 v43, v43
    v_exp_f32 v44, v44
    v_mfma_f32_32x32x16_bf16 v[24:39], v[204:207], v[16:19], 0
    v_exp_f32 v45, v45
    v_exp_f32 v46, v46
    v_exp_f32 v47, v47
    v_exp_f32 v48, v48
    v_exp_f32 v49, v49
    v_exp_f32 v50, v50
    v_smfmac_f32_32x32x32_bf16 v[144:159], v[208:211], v[40:47], v3
    v_exp_f32 v51, v51
    v_exp_f32 v52, v52
    v_exp_f32 v53, v53
    v_exp_f32 v54, v54
    v_exp_f32 v55, v55
    v_exp_f32 v24, v24
    v_exp_f32 v25, v25
    v_smfmac_f32_32x32x32_bf16 v[144:159], v[212:215], v[48:55], v3
    v_exp_f32 v26, v26
    v_exp_f32 v27, v27
    v_exp_f32 v28, v28
    v_mfma_f32_32x32x16_bf16 v[40:55], v[204:207], v[20:23], 0
    v_exp_f32 v29, v29
    v_exp_f32 v30, v30
    v_exp_f32 v31, v31
    v_exp_f32 v32, v32
    v_exp_f32 v33, v33
    v_exp_f32 v34, v34
    v_smfmac_f32_32x32x32_bf16 v[160:175], v[208:211], v[24:31], v3
    v_exp_f32 v35, v35
    v_exp_f32 v36, v36
    v_exp_f32 v37, v37
    v_exp_f32 v38, v38
    v_exp_f32 v39, v39
    v_exp_f32 v40, v40
    v_exp_f32 v41, v41
    v_smfmac_f32_32x32x32_bf16 v[160:175], v[212:215], v[32:39], v3
    v_exp_f32 v42, v42
    v_exp_f32 v43, v43
    v_exp_f32 v44, v44
    s_waitcnt vmcnt(12)
    v_mfma_f32_32x32x16_bf16 v[24:39], v[72:75], v[8:11], 0
    v_exp_f32 v45, v45
    v_exp_f32 v46, v46
    v_exp_f32 v47, v47
    v_exp_f32 v48, v48
    v_exp_f32 v49, v49
    v_exp_f32 v50, v50
    v_smfmac_f32_32x32x32_bf16 v[176:191], v[208:211], v[40:47], v3
    v_exp_f32 v51, v51
    v_exp_f32 v52, v52
    v_exp_f32 v53, v53
    v_exp_f32 v54, v54
    v_exp_f32 v55, v55
    v_exp_f32 v24, v24
    v_exp_f32 v25, v25
    v_smfmac_f32_32x32x32_bf16 v[176:191], v[212:215], v[48:55], v3
    v_exp_f32 v26, v26
    v_exp_f32 v27, v27
    v_exp_f32 v28, v28
    buffer_load_dwordx4 v[204:207], v252, s[56:59], s82 offen offset:0 sc1
    s_mov_b64 exec, s[70:71]
    buffer_load_dwordx4 v[208:211], v2, s[56:59], s82 offen offset:1024 sc1
    buffer_load_dwordx4 v[212:215], v2, s[56:59], s82 offen offset:1536 sc1
    s_mov_b64 exec, -1
    s_add_u32 s82, s82, 2048
    v_mfma_f32_32x32x16_bf16 v[40:55], v[72:75], v[12:15], 0
    v_exp_f32 v29, v29
    v_exp_f32 v30, v30
    v_exp_f32 v31, v31
    v_exp_f32 v32, v32
    v_exp_f32 v33, v33
    s_lshl_b32 s76, s60, 17
    s_lshl_b32 s73, s67, 7
    s_add_u32 s76, s76, s73
    s_lshl_b32 s77, s60, 14
    s_add_u32 m0, s77, 0
    s_add_u32 s73, s76, 0
    buffer_load_dwordx4 v126, s[32:35], s73 offen offset:0 lds
    s_add_u32 s73, s76, 7168
    buffer_load_dwordx4 v126, s[32:35], s73 offen offset:1024 lds
    v_exp_f32 v34, v34
    v_smfmac_f32_32x32x32_bf16 v[128:143], v[76:79], v[24:31], v3
    v_exp_f32 v35, v35
    v_exp_f32 v36, v36
    v_exp_f32 v37, v37
    v_exp_f32 v38, v38
    v_exp_f32 v39, v39
    v_exp_f32 v40, v40
    v_exp_f32 v41, v41
    v_smfmac_f32_32x32x32_bf16 v[128:143], v[80:83], v[32:39], v3
    v_exp_f32 v42, v42
    v_exp_f32 v43, v43
    v_exp_f32 v44, v44
    v_mfma_f32_32x32x16_bf16 v[24:39], v[72:75], v[16:19], 0
    v_exp_f32 v45, v45
    v_exp_f32 v46, v46
    v_exp_f32 v47, v47
    s_add_u32 m0, s84, 0
    s_add_u32 s72, s85, 0
    buffer_load_dwordx4 v4, s[44:47], s72 offen offset:0 lds
    s_add_u32 s72, s72, 7168
    buffer_load_dwordx4 v4, s[44:47], s72 offen offset:1024 lds
    v_exp_f32 v48, v48
    v_exp_f32 v49, v49
    s_add_u32 m0, s77, 2048
    s_add_u32 s73, s76, 16384
    buffer_load_dwordx4 v126, s[32:35], s73 offen offset:0 lds
    s_add_u32 s73, s76, 23552
    buffer_load_dwordx4 v126, s[32:35], s73 offen offset:1024 lds
    v_exp_f32 v50, v50
    v_smfmac_f32_32x32x32_bf16 v[144:159], v[76:79], v[40:47], v3
    v_exp_f32 v51, v51
    v_exp_f32 v52, v52
    v_exp_f32 v53, v53
    v_exp_f32 v54, v54
    v_exp_f32 v55, v55
    v_exp_f32 v24, v24
    v_exp_f32 v25, v25
    v_smfmac_f32_32x32x32_bf16 v[144:159], v[80:83], v[48:55], v3
    v_exp_f32 v26, v26
    v_exp_f32 v27, v27
    v_exp_f32 v28, v28
    v_mfma_f32_32x32x16_bf16 v[40:55], v[72:75], v[20:23], 0
    v_exp_f32 v29, v29
    v_exp_f32 v30, v30
    v_exp_f32 v31, v31
    s_add_u32 m0, s84, 2048
    s_add_u32 s72, s85, 65536
    buffer_load_dwordx4 v4, s[44:47], s72 offen offset:0 lds
    s_add_u32 s72, s72, 7168
    buffer_load_dwordx4 v4, s[44:47], s72 offen offset:1024 lds
    v_exp_f32 v32, v32
    v_exp_f32 v33, v33
    s_add_u32 m0, s77, 4096
    s_add_u32 s73, s76, 32768
    buffer_load_dwordx4 v126, s[32:35], s73 offen offset:0 lds
    s_add_u32 s73, s76, 39936
    buffer_load_dwordx4 v126, s[32:35], s73 offen offset:1024 lds
    v_exp_f32 v34, v34
    v_smfmac_f32_32x32x32_bf16 v[160:175], v[76:79], v[24:31], v3
    v_exp_f32 v35, v35
    v_exp_f32 v36, v36
    v_exp_f32 v37, v37
    v_exp_f32 v38, v38
    v_exp_f32 v39, v39
    v_exp_f32 v40, v40
    v_exp_f32 v41, v41
    v_smfmac_f32_32x32x32_bf16 v[160:175], v[80:83], v[32:39], v3
    v_exp_f32 v42, v42
    v_exp_f32 v43, v43
    v_exp_f32 v44, v44
    s_waitcnt vmcnt(22)
    v_mfma_f32_32x32x16_bf16 v[24:39], v[84:87], v[8:11], 0
    v_exp_f32 v45, v45
    v_exp_f32 v46, v46
    v_exp_f32 v47, v47
    v_exp_f32 v48, v48
    v_exp_f32 v49, v49
    s_add_u32 m0, s77, 6144
    s_add_u32 s73, s76, 49152
    buffer_load_dwordx4 v126, s[32:35], s73 offen offset:0 lds
    s_add_u32 s73, s76, 56320
    buffer_load_dwordx4 v126, s[32:35], s73 offen offset:1024 lds
    v_exp_f32 v50, v50
    v_smfmac_f32_32x32x32_bf16 v[176:191], v[76:79], v[40:47], v3
    v_exp_f32 v51, v51
    v_exp_f32 v52, v52
    v_exp_f32 v53, v53
    v_exp_f32 v54, v54
    v_exp_f32 v55, v55
    v_exp_f32 v24, v24
    v_exp_f32 v25, v25
    v_smfmac_f32_32x32x32_bf16 v[176:191], v[80:83], v[48:55], v3
    v_exp_f32 v26, v26
    v_exp_f32 v27, v27
    v_exp_f32 v28, v28
    v_mfma_f32_32x32x16_bf16 v[40:55], v[84:87], v[12:15], 0
    v_exp_f32 v29, v29
    v_exp_f32 v30, v30
    v_exp_f32 v31, v31
    v_exp_f32 v32, v32
    v_and_b32 v7, 31, v0
    v_lshlrev_b32 v7, 4, v7
    buffer_load_dword v7, v7, s[56:59], s87 offen offset:0 sc0 sc1
    v_exp_f32 v33, v33
    s_add_u32 m0, s77, 8192
    s_add_u32 s73, s76, 65536
    buffer_load_dwordx4 v126, s[32:35], s73 offen offset:0 lds
    s_add_u32 s73, s76, 72704
    buffer_load_dwordx4 v126, s[32:35], s73 offen offset:1024 lds
    v_exp_f32 v34, v34
    v_smfmac_f32_32x32x32_bf16 v[128:143], v[88:91], v[24:31], v3
    v_exp_f32 v35, v35
    v_exp_f32 v36, v36
    v_exp_f32 v37, v37
    v_exp_f32 v38, v38
    v_exp_f32 v39, v39
    v_exp_f32 v40, v40
    v_exp_f32 v41, v41
    v_smfmac_f32_32x32x32_bf16 v[128:143], v[92:95], v[32:39], v3
    v_exp_f32 v42, v42
    v_exp_f32 v43, v43
    v_exp_f32 v44, v44
    v_mfma_f32_32x32x16_bf16 v[24:39], v[84:87], v[16:19], 0
    v_exp_f32 v45, v45
    v_exp_f32 v46, v46
    v_exp_f32 v47, v47
    s_add_u32 m0, s84, 4096
    s_add_u32 s72, s85, 131072
    buffer_load_dwordx4 v4, s[44:47], s72 offen offset:0 lds
    s_add_u32 s72, s72, 7168
    buffer_load_dwordx4 v4, s[44:47], s72 offen offset:1024 lds
    v_exp_f32 v48, v48
    v_exp_f32 v49, v49
    s_add_u32 m0, s77, 10240
    s_add_u32 s73, s76, 81920
    buffer_load_dwordx4 v126, s[32:35], s73 offen offset:0 lds
    s_add_u32 s73, s76, 89088
    buffer_load_dwordx4 v126, s[32:35], s73 offen offset:1024 lds
    v_exp_f32 v50, v50
    v_smfmac_f32_32x32x32_bf16 v[144:159], v[88:91], v[40:47], v3
    v_exp_f32 v51, v51
    v_exp_f32 v52, v52
    v_exp_f32 v53, v53
    v_exp_f32 v54, v54
    v_exp_f32 v55, v55
    v_exp_f32 v24, v24
    v_exp_f32 v25, v25
    v_smfmac_f32_32x32x32_bf16 v[144:159], v[92:95], v[48:55], v3
    v_exp_f32 v26, v26
    v_exp_f32 v27, v27
    v_exp_f32 v28, v28
    v_mfma_f32_32x32x16_bf16 v[40:55], v[84:87], v[20:23], 0
    v_exp_f32 v29, v29
    v_exp_f32 v30, v30
    v_exp_f32 v31, v31
    s_add_u32 m0, s84, 6144
    s_add_u32 s72, s85, 196608
    buffer_load_dwordx4 v4, s[44:47], s72 offen offset:0 lds
    s_add_u32 s72, s72, 7168
    buffer_load_dwordx4 v4, s[44:47], s72 offen offset:1024 lds
    v_exp_f32 v32, v32
    v_exp_f32 v33, v33
    s_add_u32 m0, s77, 12288
    s_add_u32 s73, s76, 98304
    buffer_load_dwordx4 v126, s[32:35], s73 offen offset:0 lds
    s_add_u32 s73, s76, 105472
    buffer_load_dwordx4 v126, s[32:35], s73 offen offset:1024 lds
    v_exp_f32 v34, v34
    v_smfmac_f32_32x32x32_bf16 v[160:175], v[88:91], v[24:31], v3
    v_exp_f32 v35, v35
    v_exp_f32 v36, v36
    v_exp_f32 v37, v37
    v_exp_f32 v38, v38
    v_exp_f32 v39, v39
    v_exp_f32 v40, v40
    v_exp_f32 v41, v41
    v_smfmac_f32_32x32x32_bf16 v[160:175], v[92:95], v[32:39], v3
    v_exp_f32 v42, v42
    v_exp_f32 v43, v43
    v_exp_f32 v44, v44
    s_waitcnt vmcnt(31)
    v_mfma_f32_32x32x16_bf16 v[24:39], v[216:219], v[8:11], 0
    v_exp_f32 v45, v45
    v_exp_f32 v46, v46
    v_exp_f32 v47, v47
    v_exp_f32 v48, v48
    v_exp_f32 v49, v49
    s_add_u32 m0, s77, 14336
    s_add_u32 s73, s76, 114688
    buffer_load_dwordx4 v126, s[32:35], s73 offen offset:0 lds
    s_add_u32 s73, s76, 121856
    buffer_load_dwordx4 v126, s[32:35], s73 offen offset:1024 lds
    v_exp_f32 v50, v50
    v_smfmac_f32_32x32x32_bf16 v[176:191], v[88:91], v[40:47], v3
    v_exp_f32 v51, v51
    v_exp_f32 v52, v52
    s_waitcnt vmcnt(12)
    v_cmp_ne_u32 vcc, s68, v7
    s_cbranch_vccnz L_poll_h
L_polled_h:
    v_exp_f32 v53, v53
    v_exp_f32 v54, v54
    v_exp_f32 v55, v55
    v_exp_f32 v24, v24
    v_exp_f32 v25, v25
    v_smfmac_f32_32x32x32_bf16 v[176:191], v[92:95], v[48:55], v3
    v_exp_f32 v26, v26
    v_exp_f32 v27, v27
    v_exp_f32 v28, v28
    v_mfma_f32_32x32x16_bf16 v[40:55], v[216:219], v[12:15], 0
    v_exp_f32 v29, v29
    v_exp_f32 v30, v30
    v_exp_f32 v31, v31
    buffer_load_dwordx4 v[228:231], v1, s[56:59], s86 offen offset:0 sc1
    buffer_load_dwordx4 v[232:235], v1, s[56:59], s86 offen offset:1024 sc1
    v_exp_f32 v32, v32
    v_exp_f32 v33, v33
    v_exp_f32 v34, v34
    v_smfmac_f32_32x32x32_bf16 v[128:143], v[220:223], v[24:31], v3
    v_exp_f32 v35, v35
    v_exp_f32 v36, v36
    v_exp_f32 v37, v37
    v_exp_f32 v38, v38
    v_exp_f32 v39, v39
    v_exp_f32 v40, v40
    v_exp_f32 v41, v41
    v_smfmac_f32_32x32x32_bf16 v[128:143], v[224:227], v[32:39], v3
    v_exp_f32 v42, v42
    v_exp_f32 v43, v43
    v_exp_f32 v44, v44
    v_mfma_f32_32x32x16_bf16 v[24:39], v[216:219], v[16:19], 0
    v_exp_f32 v45, v45
    v_exp_f32 v46, v46
    v_exp_f32 v47, v47
    s_add_u32 s86, s86, 0x40000
    buffer_load_dwordx4 v[236:239], v1, s[56:59], s86 offen offset:0 sc1
    buffer_load_dwordx4 v[240:243], v1, s[56:59], s86 offen offset:1024 sc1
    v_exp_f32 v48, v48
    v_exp_f32 v49, v49
    v_exp_f32 v50, v50
    v_smfmac_f32_32x32x32_bf16 v[144:159], v[220:223], v[40:47], v3
    v_exp_f32 v51, v51
    v_exp_f32 v52, v52
    v_exp_f32 v53, v53
    v_exp_f32 v54, v54
    v_exp_f32 v55, v55
    v_exp_f32 v24, v24
    v_exp_f32 v25, v25
    v_smfmac_f32_32x32x32_bf16 v[144:159], v[224:227], v[48:55], v3
    v_exp_f32 v26, v26
    v_exp_f32 v27, v27
    v_exp_f32 v28, v28
    v_mfma_f32_32x32x16_bf16 v[40:55], v[216:219], v[20:23], 0
    v_exp_f32 v29, v29
    v_exp_f32 v30, v30
    v_exp_f32 v31, v31
    s_add_u32 s86, s86, 0x40000
    buffer_load_dwordx4 v[244:247], v1, s[56:59], s86 offen offset:0 sc1
    buffer_load_dwordx4 v[248:251], v1, s[56:59], s86 offen offset:1024 sc1
    v_exp_f32 v32, v32
    v_exp_f32 v33, v33
    v_exp_f32 v34, v34
    v_smfmac_f32_32x32x32_bf16 v[160:175], v[220:223], v[24:31], v3
    v_exp_f32 v35, v35
    v_exp_f32 v36, v36
    v_exp_f32 v37, v37
    v_exp_f32 v38, v38
    v_exp_f32 v39, v39
    v_exp_f32 v40, v40
    v_exp_f32 v41, v41
    v_smfmac_f32_32x32x32_bf16 v[160:175], v[224:227], v[32:39], v3
    v_exp_f32 v42, v42
    v_exp_f32 v43, v43
    v_exp_f32 v44, v44
    v_mfma_f32_32x32x16_bf16 v[24:39], v[192:195], v[8:11], 0
    v_exp_f32 v45, v45
    v_exp_f32 v46, v46
    v_exp_f32 v47, v47
    ds_read_b64_tr_b16 v[56:57], v5 offset:0
    ds_read_b64_tr_b16 v[58:59], v5 offset:1024
    ds_read_b64_tr_b16 v[60:61], v6 offset:0
    ds_read_b64_tr_b16 v[62:63], v6 offset:1024
    v_exp_f32 v48, v48
    v_exp_f32 v49, v49
    v_exp_f32 v50, v50
    v_smfmac_f32_32x32x32_bf16 v[176:191], v[220:223], v[40:47], v3
    v_exp_f32 v51, v51
    v_exp_f32 v52, v52
    v_exp_f32 v53, v53
    v_exp_f32 v54, v54
    v_exp_f32 v55, v55
    v_exp_f32 v24, v24
    v_exp_f32 v25, v25
    v_smfmac_f32_32x32x32_bf16 v[176:191], v[224:227], v[48:55], v3
    v_exp_f32 v26, v26
    v_exp_f32 v27, v27
    v_exp_f32 v28, v28
    buffer_load_dwordx4 v[216:219], v252, s[56:59], s82 offen offset:0 sc1
    s_mov_b64 exec, s[70:71]
    buffer_load_dwordx4 v[220:223], v2, s[56:59], s82 offen offset:1024 sc1
    buffer_load_dwordx4 v[224:227], v2, s[56:59], s82 offen offset:1536 sc1
    s_mov_b64 exec, -1
    s_add_u32 s82, s82, 2048
    v_mfma_f32_32x32x16_bf16 v[40:55], v[192:195], v[12:15], 0
    v_exp_f32 v29, v29
    v_exp_f32 v30, v30
    v_exp_f32 v31, v31
    s_waitcnt vmcnt(7)
    s_waitcnt lgkmcnt(2)
    v_mfma_f32_32x32x16_bf16 v[64:79], v[56:59], v[228:231], 0
    v_exp_f32 v32, v32
    v_exp_f32 v33, v33
    v_exp_f32 v34, v34
    v_smfmac_f32_32x32x32_bf16 v[128:143], v[196:199], v[24:31], v3
    v_exp_f32 v35, v35
    v_exp_f32 v36, v36
    v_exp_f32 v37, v37
    v_mfma_f32_32x32x16_bf16 v[96:111], v[56:59], v[232:235], 0
    v_exp_f32 v38, v38
    v_exp_f32 v39, v39
    v_exp_f32 v40, v40
    v_exp_f32 v41, v41
    ds_read_b64_tr_b16 v[56:57], v5 offset:2048
    ds_read_b64_tr_b16 v[58:59], v5 offset:3072
    v_smfmac_f32_32x32x32_bf16 v[128:143], v[200:203], v[32:39], v3
    v_exp_f32 v42, v42
    v_exp_f32 v43, v43
    v_exp_f32 v44, v44
    v_mfma_f32_32x32x16_bf16 v[24:39], v[192:195], v[16:19], 0
    v_exp_f32 v45, v45
    v_exp_f32 v46, v46
    v_exp_f32 v47, v47
    s_waitcnt lgkmcnt(2)
    v_mfma_f32_32x32x16_bf16 v[112:127], v[60:63], v[232:235], 0
    v_exp_f32 v48, v48
    v_exp_f32 v49, v49
    v_exp_f32 v50, v50
    s_add_u32 m0, s84, 0
    s_add_u32 s72, s85, 262144
    buffer_load_dwordx4 v4, s[44:47], s72 offen offset:0 lds
    s_add_u32 s72, s72, 7168
    buffer_load_dwordx4 v4, s[44:47], s72 offen offset:1024 lds
    v_smfmac_f32_32x32x32_bf16 v[144:159], v[196:199], v[40:47], v3
    v_exp_f32 v51, v51
    v_exp_f32 v52, v52
    v_exp_f32 v53, v53
    v_mfma_f32_32x32x16_bf16 v[80:95], v[60:63], v[228:231], 0
    v_exp_f32 v54, v54
    v_exp_f32 v55, v55
    v_exp_f32 v24, v24
    v_exp_f32 v25, v25
    ds_read_b64_tr_b16 v[60:61], v6 offset:2048
    ds_read_b64_tr_b16 v[62:63], v6 offset:3072
    s_add_u32 s86, s86, 0x40000
    buffer_load_dwordx4 v[228:231], v1, s[56:59], s86 offen offset:0 sc1
    buffer_load_dwordx4 v[232:235], v1, s[56:59], s86 offen offset:1024 sc1
    v_smfmac_f32_32x32x32_bf16 v[144:159], v[200:203], v[48:55], v3
    v_exp_f32 v26, v26
    v_exp_f32 v27, v27
    v_exp_f32 v28, v28
    v_mfma_f32_32x32x16_bf16 v[40:55], v[192:195], v[20:23], 0
    v_exp_f32 v29, v29
    v_exp_f32 v30, v30
    v_exp_f32 v31, v31
    s_waitcnt vmcnt(9)
    s_waitcnt lgkmcnt(2)
    v_mfma_f32_32x32x16_bf16 v[64:79], v[56:59], v[236:239], v[64:79]
    v_exp_f32 v32, v32
    v_exp_f32 v33, v33
    v_exp_f32 v34, v34
    v_smfmac_f32_32x32x32_bf16 v[160:175], v[196:199], v[24:31], v3
    v_exp_f32 v35, v35
    v_exp_f32 v36, v36
    v_exp_f32 v37, v37
    v_mfma_f32_32x32x16_bf16 v[96:111], v[56:59], v[240:243], v[96:111]
    v_exp_f32 v38, v38
    v_exp_f32 v39, v39
    v_exp_f32 v40, v40
    v_exp_f32 v41, v41
    ds_read_b64_tr_b16 v[56:57], v5 offset:4096
    ds_read_b64_tr_b16 v[58:59], v5 offset:5120
    v_smfmac_f32_32x32x32_bf16 v[160:175], v[200:203], v[32:39], v3
    v_exp_f32 v42, v42
    v_exp_f32 v43, v43
    v_exp_f32 v44, v44
    v_mfma_f32_32x32x16_bf16 v[24:39], v[204:207], v[8:11], 0
    v_exp_f32 v45, v45
    v_exp_f32 v46, v46
    v_exp_f32 v47, v47
    s_waitcnt lgkmcnt(2)
    v_mfma_f32_32x32x16_bf16 v[112:127], v[60:63], v[240:243], v[112:127]
    v_exp_f32 v48, v48
    v_exp_f32 v49, v49
    v_exp_f32 v50, v50
    s_add_u32 m0, s84, 2048
    s_add_u32 s72, s85, 327680
    buffer_load_dwordx4 v4, s[44:47], s72 offen offset:0 lds
    s_add_u32 s72, s72, 7168
    buffer_load_dwordx4 v4, s[44:47], s72 offen offset:1024 lds
    v_smfmac_f32_32x32x32_bf16 v[176:191], v[196:199], v[40:47], v3
    v_exp_f32 v51, v51
    v_exp_f32 v52, v52
    v_exp_f32 v53, v53
    v_mfma_f32_32x32x16_bf16 v[80:95], v[60:63], v[236:239], v[80:95]
    v_exp_f32 v54, v54
    v_exp_f32 v55, v55
    v_exp_f32 v24, v24
    v_exp_f32 v25, v25
    ds_read_b64_tr_b16 v[60:61], v6 offset:4096
    ds_read_b64_tr_b16 v[62:63], v6 offset:5120
    s_add_u32 s86, s86, 0x40000
    buffer_load_dwordx4 v[236:239], v1, s[56:59], s86 offen offset:0 sc1
    buffer_load_dwordx4 v[240:243], v1, s[56:59], s86 offen offset:1024 sc1
    v_smfmac_f32_32x32x32_bf16 v[176:191], v[200:203], v[48:55], v3
    v_exp_f32 v26, v26
    v_exp_f32 v27, v27
    v_exp_f32 v28, v28
    buffer_load_dwordx4 v[192:195], v252, s[56:59], s82 offen offset:0 sc1
    s_mov_b64 exec, s[70:71]
    buffer_load_dwordx4 v[196:199], v2, s[56:59], s82 offen offset:1024 sc1
    buffer_load_dwordx4 v[200:203], v2, s[56:59], s82 offen offset:1536 sc1
    s_mov_b64 exec, -1
    s_add_u32 s82, s82, 2048
    v_mfma_f32_32x32x16_bf16 v[40:55], v[204:207], v[12:15], 0
    v_exp_f32 v29, v29
    v_exp_f32 v30, v30
    v_exp_f32 v31, v31
    s_waitcnt vmcnt(14)
    s_waitcnt lgkmcnt(2)
    v_mfma_f32_32x32x16_bf16 v[64:79], v[56:59], v[244:247], v[64:79]
    v_exp_f32 v32, v32
    v_exp_f32 v33, v33
    v_exp_f32 v34, v34
    v_smfmac_f32_32x32x32_bf16 v[128:143], v[208:211], v[24:31], v3
    v_exp_f32 v35, v35
    v_exp_f32 v36, v36
    v_exp_f32 v37, v37
    v_mfma_f32_32x32x16_bf16 v[96:111], v[56:59], v[248:251], v[96:111]
    v_exp_f32 v38, v38
    v_exp_f32 v39, v39
    v_exp_f32 v40, v40
    v_exp_f32 v41, v41
    ds_read_b64_tr_b16 v[56:57], v5 offset:6144
    ds_read_b64_tr_b16 v[58:59], v5 offset:7168
    v_smfmac_f32_32x32x32_bf16 v[128:143], v[212:215], v[32:39], v3
    v_exp_f32 v42, v42
    v_exp_f32 v43, v43
    v_exp_f32 v44, v44
    v_mfma_f32_32x32x16_bf16 v[24:39], v[204:207], v[16:19], 0
    v_exp_f32 v45, v45
    v_exp_f32 v46, v46
    v_exp_f32 v47, v47
    s_waitcnt lgkmcnt(2)
    v_mfma_f32_32x32x16_bf16 v[112:127], v[60:63], v[248:251], v[112:127]
    v_exp_f32 v48, v48
    v_exp_f32 v49, v49
    v_exp_f32 v50, v50
    s_add_u32 m0, s84, 4096
    s_add_u32 s72, s85, 393216
    buffer_load_dwordx4 v4, s[44:47], s72 offen offset:0 lds
    s_add_u32 s72, s72, 7168
    buffer_load_dwordx4 v4, s[44:47], s72 offen offset:1024 lds
    v_smfmac_f32_32x32x32_bf16 v[144:159], v[208:211], v[40:47], v3
    v_exp_f32 v51, v51
    v_exp_f32 v52, v52
    v_exp_f32 v53, v53
    v_mfma_f32_32x32x16_bf16 v[80:95], v[60:63], v[244:247], v[80:95]
    v_exp_f32 v54, v54
    v_exp_f32 v55, v55
    v_exp_f32 v24, v24
    v_exp_f32 v25, v25
    ds_read_b64_tr_b16 v[60:61], v6 offset:6144
    ds_read_b64_tr_b16 v[62:63], v6 offset:7168
    s_add_u32 s86, s86, 0x40000
    buffer_load_dwordx4 v[244:247], v1, s[56:59], s86 offen offset:0 sc1
    buffer_load_dwordx4 v[248:251], v1, s[56:59], s86 offen offset:1024 sc1
    v_smfmac_f32_32x32x32_bf16 v[144:159], v[212:215], v[48:55], v3
    v_exp_f32 v26, v26
    v_exp_f32 v27, v27
    v_exp_f32 v28, v28
    v_mfma_f32_32x32x16_bf16 v[40:55], v[204:207], v[20:23], 0
    v_exp_f32 v29, v29
    v_exp_f32 v30, v30
    v_exp_f32 v31, v31
    s_waitcnt vmcnt(11)
    s_waitcnt lgkmcnt(2)
    v_mfma_f32_32x32x16_bf16 v[64:79], v[56:59], v[228:231], v[64:79]
    v_exp_f32 v32, v32
    v_exp_f32 v33, v33
    v_exp_f32 v34, v34
    v_smfmac_f32_32x32x32_bf16 v[160:175], v[208:211], v[24:31], v3
    v_exp_f32 v35, v35
    v_exp_f32 v36, v36
    v_exp_f32 v37, v37
    v_mfma_f32_32x32x16_bf16 v[96:111], v[56:59], v[232:235], v[96:111]
    v_exp_f32 v38, v38
    v_exp_f32 v39, v39
    v_exp_f32 v40, v40
    v_exp_f32 v41, v41
    ds_read_b64_tr_b16 v[56:57], v5 offset:0
    ds_read_b64_tr_b16 v[58:59], v5 offset:1024
    v_smfmac_f32_32x32x32_bf16 v[160:175], v[212:215], v[32:39], v3
    v_exp_f32 v42, v42
    v_exp_f32 v43, v43
    v_exp_f32 v44, v44
    v_mfma_f32_32x32x16_bf16 v[24:39], v[216:219], v[8:11], 0
    v_exp_f32 v45, v45
    v_exp_f32 v46, v46
    v_exp_f32 v47, v47
    s_waitcnt lgkmcnt(2)
    v_mfma_f32_32x32x16_bf16 v[112:127], v[60:63], v[232:235], v[112:127]
    v_exp_f32 v48, v48
    v_exp_f32 v49, v49
    v_exp_f32 v50, v50
    s_add_u32 m0, s84, 6144
    s_add_u32 s72, s85, 458752
    buffer_load_dwordx4 v4, s[44:47], s72 offen offset:0 lds
    s_add_u32 s72, s72, 7168
    buffer_load_dwordx4 v4, s[44:47], s72 offen offset:1024 lds
    v_smfmac_f32_32x32x32_bf16 v[176:191], v[208:211], v[40:47], v3
    v_exp_f32 v51, v51
    v_exp_f32 v52, v52
    v_exp_f32 v53, v53
    v_mfma_f32_32x32x16_bf16 v[80:95], v[60:63], v[228:231], v[80:95]
    v_exp_f32 v54, v54
    v_exp_f32 v55, v55
    v_exp_f32 v24, v24
    v_exp_f32 v25, v25
    ds_read_b64_tr_b16 v[60:61], v6 offset:0
    ds_read_b64_tr_b16 v[62:63], v6 offset:1024
    s_add_u32 s86, s86, 0x40000
    buffer_load_dwordx4 v[228:231], v1, s[56:59], s86 offen offset:0 sc1
    buffer_load_dwordx4 v[232:235], v1, s[56:59], s86 offen offset:1024 sc1
    v_smfmac_f32_32x32x32_bf16 v[176:191], v[212:215], v[48:55], v3
    v_exp_f32 v26, v26
    v_exp_f32 v27, v27
    v_exp_f32 v28, v28
    buffer_load_dwordx4 v[204:207], v252, s[56:59], s82 offen offset:0 sc1
    s_mov_b64 exec, s[70:71]
    buffer_load_dwordx4 v[208:211], v2, s[56:59], s82 offen offset:1024 sc1
    buffer_load_dwordx4 v[212:215], v2, s[56:59], s82 offen offset:1536 sc1
    s_mov_b64 exec, -1
    s_add_u32 s82, s82, 2048
    v_mfma_f32_32x32x16_bf16 v[40:55], v[216:219], v[12:15], 0
    v_exp_f32 v29, v29
    v_exp_f32 v30, v30
    v_exp_f32 v31, v31
    s_waitcnt vmcnt(14)
    s_waitcnt lgkmcnt(2)
    v_mfma_f32_32x32x16_bf16 v[64:79], v[56:59], v[236:239], v[64:79]
    v_exp_f32 v32, v32
    v_exp_f32 v33, v33
    v_exp_f32 v34, v34
    v_smfmac_f32_32x32x32_bf16 v[128:143], v[220:223], v[24:31], v3
    v_exp_f32 v35, v35
    v_exp_f32 v36, v36
    v_exp_f32 v37, v37
    v_mfma_f32_32x32x16_bf16 v[96:111], v[56:59], v[240:243], v[96:111]
    v_exp_f32 v38, v38
    v_exp_f32 v39, v39
    v_exp_f32 v40, v40
    v_exp_f32 v41, v41
    ds_read_b64_tr_b16 v[56:57], v5 offset:2048
    ds_read_b64_tr_b16 v[58:59], v5 offset:3072
    v_smfmac_f32_32x32x32_bf16 v[128:143], v[224:227], v[32:39], v3
    v_exp_f32 v42, v42
    v_exp_f32 v43, v43
    v_exp_f32 v44, v44
    v_mfma_f32_32x32x16_bf16 v[24:39], v[216:219], v[16:19], 0
    v_exp_f32 v45, v45
    v_exp_f32 v46, v46
    v_exp_f32 v47, v47
    s_waitcnt lgkmcnt(2)
    v_mfma_f32_32x32x16_bf16 v[112:127], v[60:63], v[240:243], v[112:127]
    v_exp_f32 v48, v48
    v_exp_f32 v49, v49
    v_exp_f32 v50, v50
    s_add_u32 m0, s84, 0
    s_add_u32 s72, s85, 524288
    buffer_load_dwordx4 v4, s[44:47], s72 offen offset:0 lds
    s_add_u32 s72, s72, 7168
    buffer_load_dwordx4 v4, s[44:47], s72 offen offset:1024 lds
    v_smfmac_f32_32x32x32_bf16 v[144:159], v[220:223], v[40:47], v3
    v_exp_f32 v51, v51
    v_exp_f32 v52, v52
    v_exp_f32 v53, v53
    v_mfma_f32_32x32x16_bf16 v[80:95], v[60:63], v[236:239], v[80:95]
    v_exp_f32 v54, v54
    v_exp_f32 v55, v55
    v_exp_f32 v24, v24
    v_exp_f32 v25, v25
    ds_read_b64_tr_b16 v[60:61], v6 offset:2048
    ds_read_b64_tr_b16 v[62:63], v6 offset:3072
    s_add_u32 s86, s86, 0x40000
    buffer_load_dwordx4 v[236:239], v1, s[56:59], s86 offen offset:0 sc1
    buffer_load_dwordx4 v[240:243], v1, s[56:59], s86 offen offset:1024 sc1
    v_smfmac_f32_32x32x32_bf16 v[144:159], v[224:227], v[48:55], v3
    v_exp_f32 v26, v26
    v_exp_f32 v27, v27
    v_exp_f32 v28, v28
    v_mfma_f32_32x32x16_bf16 v[40:55], v[216:219], v[20:23], 0
    v_exp_f32 v29, v29
    v_exp_f32 v30, v30
    v_exp_f32 v31, v31
    s_waitcnt vmcnt(11)
    s_waitcnt lgkmcnt(2)
    v_mfma_f32_32x32x16_bf16 v[64:79], v[56:59], v[244:247], v[64:79]
    v_exp_f32 v32, v32
    v_exp_f32 v33, v33
    v_exp_f32 v34, v34
    v_smfmac_f32_32x32x32_bf16 v[160:175], v[220:223], v[24:31], v3
    v_exp_f32 v35, v35
    v_exp_f32 v36, v36
    v_exp_f32 v37, v37
    v_mfma_f32_32x32x16_bf16 v[96:111], v[56:59], v[248:251], v[96:111]
    v_exp_f32 v38, v38
    v_exp_f32 v39, v39
    v_exp_f32 v40, v40
    v_exp_f32 v41, v41
    ds_read_b64_tr_b16 v[56:57], v5 offset:4096
    ds_read_b64_tr_b16 v[58:59], v5 offset:5120
    v_smfmac_f32_32x32x32_bf16 v[160:175], v[224:227], v[32:39], v3
    v_exp_f32 v42, v42
    v_exp_f32 v43, v43
    v_exp_f32 v44, v44
    v_mfma_f32_32x32x16_bf16 v[24:39], v[192:195], v[8:11], 0
    v_exp_f32 v45, v45
    v_exp_f32 v46, v46
    v_exp_f32 v47, v47
    s_waitcnt lgkmcnt(2)
    v_mfma_f32_32x32x16_bf16 v[112:127], v[60:63], v[248:251], v[112:127]
    v_exp_f32 v48, v48
    v_exp_f32 v49, v49
    v_exp_f32 v50, v50
    s_add_u32 m0, s84, 2048
    s_add_u32 s72, s85, 589824
    buffer_load_dwordx4 v4, s[44:47], s72 offen offset:0 lds
    s_add_u32 s72, s72, 7168
    buffer_load_dwordx4 v4, s[44:47], s72 offen offset:1024 lds
    v_smfmac_f32_32x32x32_bf16 v[176:191], v[220:223], v[40:47], v3
    v_exp_f32 v51, v51
    v_exp_f32 v52, v52
    v_exp_f32 v53, v53
    v_mfma_f32_32x32x16_bf16 v[80:95], v[60:63], v[244:247], v[80:95]
    v_exp_f32 v54, v54
    v_exp_f32 v55, v55
    v_exp_f32 v24, v24
    v_exp_f32 v25, v25
    ds_read_b64_tr_b16 v[60:61], v6 offset:4096
    ds_read_b64_tr_b16 v[62:63], v6 offset:5120
    s_add_u32 s86, s86, 0x40000
    buffer_load_dwordx4 v[244:247], v1, s[56:59], s86 offen offset:0 sc1
    buffer_load_dwordx4 v[248:251], v1, s[56:59], s86 offen offset:1024 sc1
    v_smfmac_f32_32x32x32_bf16 v[176:191], v[224:227], v[48:55], v3
    v_exp_f32 v26, v26
    v_exp_f32 v27, v27
    v_exp_f32 v28, v28
    buffer_load_dwordx4 v[216:219], v252, s[56:59], s82 offen offset:0 sc1
    s_mov_b64 exec, s[70:71]
    buffer_load_dwordx4 v[220:223], v2, s[56:59], s82 offen offset:1024 sc1
    buffer_load_dwordx4 v[224:227], v2, s[56:59], s82 offen offset:1536 sc1
    s_mov_b64 exec, -1
    s_add_u32 s82, s82, 2048
    v_mfma_f32_32x32x16_bf16 v[40:55], v[192:195], v[12:15], 0
    v_exp_f32 v29, v29
    v_exp_f32 v30, v30
    v_exp_f32 v31, v31
    s_waitcnt vmcnt(14)
    s_waitcnt lgkmcnt(2)
    v_mfma_f32_32x32x16_bf16 v[64:79], v[56:59], v[228:231], v[64:79]
    v_exp_f32 v32, v32
    v_exp_f32 v33, v33
    v_exp_f32 v34, v34
    v_smfmac_f32_32x32x32_bf16 v[128:143], v[196:199], v[24:31], v3
    v_exp_f32 v35, v35
    v_exp_f32 v36, v36
    v_exp_f32 v37, v37
    v_mfma_f32_32x32x16_bf16 v[96:111], v[56:59], v[232:235], v[96:111]
    v_exp_f32 v38, v38
    v_exp_f32 v39, v39
    v_exp_f32 v40, v40
    v_exp_f32 v41, v41
    ds_read_b64_tr_b16 v[56:57], v5 offset:6144
    ds_read_b64_tr_b16 v[58:59], v5 offset:7168
    v_smfmac_f32_32x32x32_bf16 v[128:143], v[200:203], v[32:39], v3
    v_exp_f32 v42, v42
    v_exp_f32 v43, v43
    v_exp_f32 v44, v44
    v_mfma_f32_32x32x16_bf16 v[24:39], v[192:195], v[16:19], 0
    v_exp_f32 v45, v45
    v_exp_f32 v46, v46
    v_exp_f32 v47, v47
    s_waitcnt lgkmcnt(2)
    v_mfma_f32_32x32x16_bf16 v[112:127], v[60:63], v[232:235], v[112:127]
    v_exp_f32 v48, v48
    v_exp_f32 v49, v49
    v_exp_f32 v50, v50
    s_add_u32 m0, s84, 4096
    s_add_u32 s72, s85, 655360
    buffer_load_dwordx4 v4, s[44:47], s72 offen offset:0 lds
    s_add_u32 s72, s72, 7168
    buffer_load_dwordx4 v4, s[44:47], s72 offen offset:1024 lds
    v_smfmac_f32_32x32x32_bf16 v[144:159], v[196:199], v[40:47], v3
    v_exp_f32 v51, v51
    v_exp_f32 v52, v52
    v_exp_f32 v53, v53
    v_mfma_f32_32x32x16_bf16 v[80:95], v[60:63], v[228:231], v[80:95]
    v_exp_f32 v54, v54
    v_exp_f32 v55, v55
    v_exp_f32 v24, v24
    v_exp_f32 v25, v25
    ds_read_b64_tr_b16 v[60:61], v6 offset:6144
    ds_read_b64_tr_b16 v[62:63], v6 offset:7168
    s_add_u32 s86, s86, 0x40000
    buffer_load_dwordx4 v[228:231], v1, s[56:59], s86 offen offset:0 sc1
    buffer_load_dwordx4 v[232:235], v1, s[56:59], s86 offen offset:1024 sc1
    v_smfmac_f32_32x32x32_bf16 v[144:159], v[200:203], v[48:55], v3
    v_exp_f32 v26, v26
    v_exp_f32 v27, v27
    v_exp_f32 v28, v28
    v_mfma_f32_32x32x16_bf16 v[40:55], v[192:195], v[20:23], 0
    v_exp_f32 v29, v29
    v_exp_f32 v30, v30
    v_exp_f32 v31, v31
    s_waitcnt vmcnt(11)
    s_waitcnt lgkmcnt(2)
    v_mfma_f32_32x32x16_bf16 v[64:79], v[56:59], v[236:239], v[64:79]
    v_exp_f32 v32, v32
    v_exp_f32 v33, v33
    v_exp_f32 v34, v34
    v_smfmac_f32_32x32x32_bf16 v[160:175], v[196:199], v[24:31], v3
    v_exp_f32 v35, v35
    v_exp_f32 v36, v36
    v_exp_f32 v37, v37
    v_mfma_f32_32x32x16_bf16 v[96:111], v[56:59], v[240:243], v[96:111]
    v_exp_f32 v38, v38
    v_exp_f32 v39, v39
    v_exp_f32 v40, v40
    v_exp_f32 v41, v41
    ds_read_b64_tr_b16 v[56:57], v5 offset:0
    ds_read_b64_tr_b16 v[58:59], v5 offset:1024
    v_smfmac_f32_32x32x32_bf16 v[160:175], v[200:203], v[32:39], v3
    v_exp_f32 v42, v42
    v_exp_f32 v43, v43
    v_exp_f32 v44, v44
    v_mfma_f32_32x32x16_bf16 v[24:39], v[204:207], v[8:11], 0
    v_exp_f32 v45, v45
    v_exp_f32 v46, v46
    v_exp_f32 v47, v47
    s_waitcnt lgkmcnt(2)
    v_mfma_f32_32x32x16_bf16 v[112:127], v[60:63], v[240:243], v[112:127]
    v_exp_f32 v48, v48
    v_exp_f32 v49, v49
    v_exp_f32 v50, v50
    s_add_u32 m0, s84, 6144
    s_add_u32 s72, s85, 720896
    buffer_load_dwordx4 v4, s[44:47], s72 offen offset:0 lds
    s_add_u32 s72, s72, 7168
    buffer_load_dwordx4 v4, s[44:47], s72 offen offset:1024 lds
    v_smfmac_f32_32x32x32_bf16 v[176:191], v[196:199], v[40:47], v3
    v_exp_f32 v51, v51
    v_exp_f32 v52, v52
    v_exp_f32 v53, v53
    v_mfma_f32_32x32x16_bf16 v[80:95], v[60:63], v[236:239], v[80:95]
    v_exp_f32 v54, v54
    v_exp_f32 v55, v55
    v_exp_f32 v24, v24
    v_exp_f32 v25, v25
    ds_read_b64_tr_b16 v[60:61], v6 offset:0
    ds_read_b64_tr_b16 v[62:63], v6 offset:1024
    s_add_u32 s86, s86, 0x40000
    buffer_load_dwordx4 v[236:239], v1, s[56:59], s86 offen offset:0 sc1
    buffer_load_dwordx4 v[240:243], v1, s[56:59], s86 offen offset:1024 sc1
    v_smfmac_f32_32x32x32_bf16 v[176:191], v[200:203], v[48:55], v3
    v_exp_f32 v26, v26
    v_exp_f32 v27, v27
    v_exp_f32 v28, v28
    buffer_load_dwordx4 v[192:195], v252, s[56:59], s82 offen offset:0 sc1
    s_mov_b64 exec, s[70:71]
    buffer_load_dwordx4 v[196:199], v2, s[56:59], s82 offen offset:1024 sc1
    buffer_load_dwordx4 v[200:203], v2, s[56:59], s82 offen offset:1536 sc1
    s_mov_b64 exec, -1
    s_add_u32 s82, s82, 2048
    v_mfma_f32_32x32x16_bf16 v[40:55], v[204:207], v[12:15], 0
    v_exp_f32 v29, v29
    v_exp_f32 v30, v30
    v_exp_f32 v31, v31
    s_waitcnt vmcnt(14)
    s_waitcnt lgkmcnt(2)
    v_mfma_f32_32x32x16_bf16 v[64:79], v[56:59], v[244:247], v[64:79]
    v_exp_f32 v32, v32
    v_exp_f32 v33, v33
    v_exp_f32 v34, v34
    v_smfmac_f32_32x32x32_bf16 v[128:143], v[208:211], v[24:31], v3
    v_exp_f32 v35, v35
    v_exp_f32 v36, v36
    v_exp_f32 v37, v37
    v_mfma_f32_32x32x16_bf16 v[96:111], v[56:59], v[248:251], v[96:111]
    v_exp_f32 v38, v38
    v_exp_f32 v39, v39
    v_exp_f32 v40, v40
    v_exp_f32 v41, v41
    ds_read_b64_tr_b16 v[56:57], v5 offset:2048
    ds_read_b64_tr_b16 v[58:59], v5 offset:3072
    v_smfmac_f32_32x32x32_bf16 v[128:143], v[212:215], v[32:39], v3
    v_exp_f32 v42, v42
    v_exp_f32 v43, v43
    v_exp_f32 v44, v44
    v_mfma_f32_32x32x16_bf16 v[24:39], v[204:207], v[16:19], 0
    v_exp_f32 v45, v45
    v_exp_f32 v46, v46
    v_exp_f32 v47, v47
    s_waitcnt lgkmcnt(2)
    v_mfma_f32_32x32x16_bf16 v[112:127], v[60:63], v[248:251], v[112:127]
    v_exp_f32 v48, v48
    v_exp_f32 v49, v49
    v_exp_f32 v50, v50
    s_add_u32 m0, s84, 0
    s_add_u32 s72, s85, 786432
    buffer_load_dwordx4 v4, s[44:47], s72 offen offset:0 lds
    s_add_u32 s72, s72, 7168
    buffer_load_dwordx4 v4, s[44:47], s72 offen offset:1024 lds
    v_smfmac_f32_32x32x32_bf16 v[144:159], v[208:211], v[40:47], v3
    v_exp_f32 v51, v51
    v_exp_f32 v52, v52
    v_exp_f32 v53, v53
    v_mfma_f32_32x32x16_bf16 v[80:95], v[60:63], v[244:247], v[80:95]
    v_exp_f32 v54, v54
    v_exp_f32 v55, v55
    v_exp_f32 v24, v24
    v_exp_f32 v25, v25
    ds_read_b64_tr_b16 v[60:61], v6 offset:2048
    ds_read_b64_tr_b16 v[62:63], v6 offset:3072
    s_add_u32 s86, s86, 0x40000
    buffer_load_dwordx4 v[244:247], v1, s[56:59], s86 offen offset:0 sc1
    buffer_load_dwordx4 v[248:251], v1, s[56:59], s86 offen offset:1024 sc1
    v_smfmac_f32_32x32x32_bf16 v[144:159], v[212:215], v[48:55], v3
    v_exp_f32 v26, v26
    v_exp_f32 v27, v27
    v_exp_f32 v28, v28
    v_mfma_f32_32x32x16_bf16 v[40:55], v[204:207], v[20:23], 0
    v_exp_f32 v29, v29
    v_exp_f32 v30, v30
    v_exp_f32 v31, v31
    s_waitcnt vmcnt(11)
    s_waitcnt lgkmcnt(2)
    v_mfma_f32_32x32x16_bf16 v[64:79], v[56:59], v[228:231], v[64:79]
    v_exp_f32 v32, v32
    v_exp_f32 v33, v33
    v_exp_f32 v34, v34
    v_smfmac_f32_32x32x32_bf16 v[160:175], v[208:211], v[24:31], v3
    v_exp_f32 v35, v35
    v_exp_f32 v36, v36
    v_exp_f32 v37, v37
    v_mfma_f32_32x32x16_bf16 v[96:111], v[56:59], v[232:235], v[96:111]
    v_exp_f32 v38, v38
    v_exp_f32 v39, v39
    v_exp_f32 v40, v40
    v_exp_f32 v41, v41
    ds_read_b64_tr_b16 v[56:57], v5 offset:4096
    ds_read_b64_tr_b16 v[58:59], v5 offset:5120
    v_smfmac_f32_32x32x32_bf16 v[160:175], v[212:215], v[32:39], v3
    v_exp_f32 v42, v42
    v_exp_f32 v43, v43
    v_exp_f32 v44, v44
    v_mfma_f32_32x32x16_bf16 v[24:39], v[216:219], v[8:11], 0
    v_exp_f32 v45, v45
    v_exp_f32 v46, v46
    v_exp_f32 v47, v47
    s_waitcnt lgkmcnt(2)
    v_mfma_f32_32x32x16_bf16 v[112:127], v[60:63], v[232:235], v[112:127]
    v_exp_f32 v48, v48
    v_exp_f32 v49, v49
    v_exp_f32 v50, v50
    s_add_u32 m0, s84, 2048
    s_add_u32 s72, s85, 851968
    buffer_load_dwordx4 v4, s[44:47], s72 offen offset:0 lds
    s_add_u32 s72, s72, 7168
    buffer_load_dwordx4 v4, s[44:47], s72 offen offset:1024 lds
    v_smfmac_f32_32x32x32_bf16 v[176:191], v[208:211], v[40:47], v3
    v_exp_f32 v51, v51
    v_exp_f32 v52, v52
    v_exp_f32 v53, v53
    v_mfma_f32_32x32x16_bf16 v[80:95], v[60:63], v[228:231], v[80:95]
    v_exp_f32 v54, v54
    v_exp_f32 v55, v55
    v_exp_f32 v24, v24
    v_exp_f32 v25, v25
    ds_read_b64_tr_b16 v[60:61], v6 offset:4096
    ds_read_b64_tr_b16 v[62:63], v6 offset:5120
    s_add_u32 s86, s86, 0x40000
    buffer_load_dwordx4 v[228:231], v1, s[56:59], s86 offen offset:0 sc1
    buffer_load_dwordx4 v[232:235], v1, s[56:59], s86 offen offset:1024 sc1
    v_smfmac_f32_32x32x32_bf16 v[176:191], v[212:215], v[48:55], v3
    v_exp_f32 v26, v26
    v_exp_f32 v27, v27
    v_exp_f32 v28, v28
    buffer_load_dwordx4 v[204:207], v252, s[56:59], s82 offen offset:0 sc1
    s_mov_b64 exec, s[70:71]
    buffer_load_dwordx4 v[208:211], v2, s[56:59], s82 offen offset:1024 sc1
    buffer_load_dwordx4 v[212:215], v2, s[56:59], s82 offen offset:1536 sc1
    s_mov_b64 exec, -1
    s_add_u32 s82, s82, 2048
    v_mfma_f32_32x32x16_bf16 v[40:55], v[216:219], v[12:15], 0
    v_exp_f32 v29, v29
    v_exp_f32 v30, v30
    v_exp_f32 v31, v31
    s_waitcnt vmcnt(14)
    s_waitcnt lgkmcnt(2)
    v_mfma_f32_32x32x16_bf16 v[64:79], v[56:59], v[236:239], v[64:79]
    v_exp_f32 v32, v32
    v_exp_f32 v33, v33
    v_exp_f32 v34, v34
    v_smfmac_f32_32x32x32_bf16 v[128:143], v[220:223], v[24:31], v3
    v_exp_f32 v35, v35
    v_exp_f32 v36, v36
    v_exp_f32 v37, v37
    v_mfma_f32_32x32x16_bf16 v[96:111], v[56:59], v[240:243], v[96:111]
    v_exp_f32 v38, v38
    v_exp_f32 v39, v39
    v_exp_f32 v40, v40
    v_exp_f32 v41, v41
    ds_read_b64_tr_b16 v[56:57], v5 offset:6144
    ds_read_b64_tr_b16 v[58:59], v5 offset:7168
    v_smfmac_f32_32x32x32_bf16 v[128:143], v[224:227], v[32:39], v3
    v_exp_f32 v42, v42
    v_exp_f32 v43, v43
    v_exp_f32 v44, v44
    v_mfma_f32_32x32x16_bf16 v[24:39], v[216:219], v[16:19], 0
    v_exp_f32 v45, v45
    v_exp_f32 v46, v46
    v_exp_f32 v47, v47
    s_waitcnt lgkmcnt(2)
    v_mfma_f32_32x32x16_bf16 v[112:127], v[60:63], v[240:243], v[112:127]
    v_exp_f32 v48, v48
    v_exp_f32 v49, v49
    v_exp_f32 v50, v50
    s_add_u32 m0, s84, 4096
    s_add_u32 s72, s85, 917504
    buffer_load_dwordx4 v4, s[44:47], s72 offen offset:0 lds
    s_add_u32 s72, s72, 7168
    buffer_load_dwordx4 v4, s[44:47], s72 offen offset:1024 lds
    v_smfmac_f32_32x32x32_bf16 v[144:159], v[220:223], v[40:47], v3
    v_exp_f32 v51, v51
    v_exp_f32 v52, v52
    v_exp_f32 v53, v53
    v_mfma_f32_32x32x16_bf16 v[80:95], v[60:63], v[236:239], v[80:95]
    v_exp_f32 v54, v54
    v_exp_f32 v55, v55
    v_exp_f32 v24, v24
    v_exp_f32 v25, v25
    ds_read_b64_tr_b16 v[60:61], v6 offset:6144
    ds_read_b64_tr_b16 v[62:63], v6 offset:7168
    s_add_u32 s86, s86, 0x40000
    buffer_load_dwordx4 v[236:239], v1, s[56:59], s86 offen offset:0 sc1
    buffer_load_dwordx4 v[240:243], v1, s[56:59], s86 offen offset:1024 sc1
    v_smfmac_f32_32x32x32_bf16 v[144:159], v[224:227], v[48:55], v3
    v_exp_f32 v26, v26
    v_exp_f32 v27, v27
    v_exp_f32 v28, v28
    v_mfma_f32_32x32x16_bf16 v[40:55], v[216:219], v[20:23], 0
    v_exp_f32 v29, v29
    v_exp_f32 v30, v30
    v_exp_f32 v31, v31
    s_waitcnt vmcnt(11)
    s_waitcnt lgkmcnt(2)
    v_mfma_f32_32x32x16_bf16 v[64:79], v[56:59], v[244:247], v[64:79]
    v_exp_f32 v32, v32
    v_exp_f32 v33, v33
    v_exp_f32 v34, v34
    v_smfmac_f32_32x32x32_bf16 v[160:175], v[220:223], v[24:31], v3
    v_exp_f32 v35, v35
    v_exp_f32 v36, v36
    v_exp_f32 v37, v37
    v_mfma_f32_32x32x16_bf16 v[96:111], v[56:59], v[248:251], v[96:111]
    v_exp_f32 v38, v38
    v_exp_f32 v39, v39
    v_exp_f32 v40, v40
    v_exp_f32 v41, v41
    ds_read_b64_tr_b16 v[56:57], v5 offset:0
    ds_read_b64_tr_b16 v[58:59], v5 offset:1024
    v_smfmac_f32_32x32x32_bf16 v[160:175], v[224:227], v[32:39], v3
    v_exp_f32 v42, v42
    v_exp_f32 v43, v43
    v_exp_f32 v44, v44
    v_mfma_f32_32x32x16_bf16 v[24:39], v[192:195], v[8:11], 0
    v_exp_f32 v45, v45
    v_exp_f32 v46, v46
    v_exp_f32 v47, v47
    s_waitcnt lgkmcnt(2)
    v_mfma_f32_32x32x16_bf16 v[112:127], v[60:63], v[248:251], v[112:127]
    v_exp_f32 v48, v48
    v_exp_f32 v49, v49
    v_exp_f32 v50, v50
    s_add_u32 m0, s84, 6144
    s_add_u32 s72, s85, 983040
    buffer_load_dwordx4 v4, s[44:47], s72 offen offset:0 lds
    s_add_u32 s72, s72, 7168
    buffer_load_dwordx4 v4, s[44:47], s72 offen offset:1024 lds
    v_smfmac_f32_32x32x32_bf16 v[176:191], v[220:223], v[40:47], v3
    v_exp_f32 v51, v51
    v_exp_f32 v52, v52
    v_exp_f32 v53, v53
    v_mfma_f32_32x32x16_bf16 v[80:95], v[60:63], v[244:247], v[80:95]
    v_exp_f32 v54, v54
    v_exp_f32 v55, v55
    v_exp_f32 v24, v24
    v_exp_f32 v25, v25
    ds_read_b64_tr_b16 v[60:61], v6 offset:0
    ds_read_b64_tr_b16 v[62:63], v6 offset:1024
    s_add_u32 s86, s86, 0x40000
    buffer_load_dwordx4 v[244:247], v1, s[56:59], s86 offen offset:0 sc1
    buffer_load_dwordx4 v[248:251], v1, s[56:59], s86 offen offset:1024 sc1
    v_smfmac_f32_32x32x32_bf16 v[176:191], v[224:227], v[48:55], v3
    v_exp_f32 v26, v26
    v_exp_f32 v27, v27
    v_exp_f32 v28, v28
    buffer_load_dwordx4 v[216:219], v252, s[56:59], s82 offen offset:0 sc1
    s_mov_b64 exec, s[70:71]
    buffer_load_dwordx4 v[220:223], v2, s[56:59], s82 offen offset:1024 sc1
    buffer_load_dwordx4 v[224:227], v2, s[56:59], s82 offen offset:1536 sc1
    s_mov_b64 exec, -1
    s_add_u32 s82, s82, 2048
    v_mfma_f32_32x32x16_bf16 v[40:55], v[192:195], v[12:15], 0
    v_exp_f32 v29, v29
    v_exp_f32 v30, v30
    v_exp_f32 v31, v31
    s_waitcnt vmcnt(14)
    s_waitcnt lgkmcnt(2)
    v_mfma_f32_32x32x16_bf16 v[64:79], v[56:59], v[228:231], v[64:79]
    v_exp_f32 v32, v32
    v_exp_f32 v33, v33
    v_exp_f32 v34, v34
    v_smfmac_f32_32x32x32_bf16 v[128:143], v[196:199], v[24:31], v3
    v_exp_f32 v35, v35
    v_exp_f32 v36, v36
    v_exp_f32 v37, v37
    v_mfma_f32_32x32x16_bf16 v[96:111], v[56:59], v[232:235], v[96:111]
    v_exp_f32 v38, v38
    v_exp_f32 v39, v39
    v_exp_f32 v40, v40
    v_exp_f32 v41, v41
    ds_read_b64_tr_b16 v[56:57], v5 offset:2048
    ds_read_b64_tr_b16 v[58:59], v5 offset:3072
    v_smfmac_f32_32x32x32_bf16 v[128:143], v[200:203], v[32:39], v3
    v_exp_f32 v42, v42
    v_exp_f32 v43, v43
    v_exp_f32 v44, v44
    v_mfma_f32_32x32x16_bf16 v[24:39], v[192:195], v[16:19], 0
    v_exp_f32 v45, v45
    v_exp_f32 v46, v46
    v_exp_f32 v47, v47
    s_waitcnt lgkmcnt(2)
    v_mfma_f32_32x32x16_bf16 v[112:127], v[60:63], v[232:235], v[112:127]
    v_exp_f32 v48, v48
    v_exp_f32 v49, v49
    v_exp_f32 v50, v50
    s_add_u32 m0, s84, 0
    s_add_u32 s72, s85, 1048576
    buffer_load_dwordx4 v4, s[44:47], s72 offen offset:0 lds
    s_add_u32 s72, s72, 7168
    buffer_load_dwordx4 v4, s[44:47], s72 offen offset:1024 lds
    v_smfmac_f32_32x32x32_bf16 v[144:159], v[196:199], v[40:47], v3
    v_exp_f32 v51, v51
    v_exp_f32 v52, v52
    v_exp_f32 v53, v53
    v_mfma_f32_32x32x16_bf16 v[80:95], v[60:63], v[228:231], v[80:95]
    v_exp_f32 v54, v54
    v_exp_f32 v55, v55
    v_exp_f32 v24, v24
    v_exp_f32 v25, v25
    ds_read_b64_tr_b16 v[60:61], v6 offset:2048
    ds_read_b64_tr_b16 v[62:63], v6 offset:3072
    s_add_u32 s86, s86, 0x40000
    buffer_load_dwordx4 v[228:231], v1, s[56:59], s86 offen offset:0 sc1
    buffer_load_dwordx4 v[232:235], v1, s[56:59], s86 offen offset:1024 sc1
    v_smfmac_f32_32x32x32_bf16 v[144:159], v[200:203], v[48:55], v3
    v_exp_f32 v26, v26
    v_exp_f32 v27, v27
    v_exp_f32 v28, v28
    v_mfma_f32_32x32x16_bf16 v[40:55], v[192:195], v[20:23], 0
    v_exp_f32 v29, v29
    v_exp_f32 v30, v30
    v_exp_f32 v31, v31
    s_waitcnt vmcnt(11)
    s_waitcnt lgkmcnt(2)
    v_mfma_f32_32x32x16_bf16 v[64:79], v[56:59], v[236:239], v[64:79]
    v_exp_f32 v32, v32
    v_exp_f32 v33, v33
    v_exp_f32 v34, v34
    v_smfmac_f32_32x32x32_bf16 v[160:175], v[196:199], v[24:31], v3
    v_exp_f32 v35, v35
    v_exp_f32 v36, v36
    v_exp_f32 v37, v37
    v_mfma_f32_32x32x16_bf16 v[96:111], v[56:59], v[240:243], v[96:111]
    v_exp_f32 v38, v38
    v_exp_f32 v39, v39
    v_exp_f32 v40, v40
    v_exp_f32 v41, v41
    ds_read_b64_tr_b16 v[56:57], v5 offset:4096
    ds_read_b64_tr_b16 v[58:59], v5 offset:5120
    v_smfmac_f32_32x32x32_bf16 v[160:175], v[200:203], v[32:39], v3
    v_exp_f32 v42, v42
    v_exp_f32 v43, v43
    v_exp_f32 v44, v44
    v_mfma_f32_32x32x16_bf16 v[24:39], v[204:207], v[8:11], 0
    v_exp_f32 v45, v45
    v_exp_f32 v46, v46
    v_exp_f32 v47, v47
    s_waitcnt lgkmcnt(2)
    v_mfma_f32_32x32x16_bf16 v[112:127], v[60:63], v[240:243], v[112:127]
    v_exp_f32 v48, v48
    v_exp_f32 v49, v49
    v_exp_f32 v50, v50
    s_add_u32 m0, s84, 2048
    s_add_u32 s72, s85, 1114112
    buffer_load_dwordx4 v4, s[44:47], s72 offen offset:0 lds
    s_add_u32 s72, s72, 7168
    buffer_load_dwordx4 v4, s[44:47], s72 offen offset:1024 lds
    v_smfmac_f32_32x32x32_bf16 v[176:191], v[196:199], v[40:47], v3
    v_exp_f32 v51, v51
    v_exp_f32 v52, v52
    v_exp_f32 v53, v53
    v_mfma_f32_32x32x16_bf16 v[80:95], v[60:63], v[236:239], v[80:95]
    v_exp_f32 v54, v54
    v_exp_f32 v55, v55
    v_exp_f32 v24, v24
    v_exp_f32 v25, v25
    ds_read_b64_tr_b16 v[60:61], v6 offset:4096
    ds_read_b64_tr_b16 v[62:63], v6 offset:5120
    s_add_u32 s86, s86, 0x40000
    buffer_load_dwordx4 v[236:239], v1, s[56:59], s86 offen offset:0 sc1
    buffer_load_dwordx4 v[240:243], v1, s[56:59], s86 offen offset:1024 sc1
    v_smfmac_f32_32x32x32_bf16 v[176:191], v[200:203], v[48:55], v3
    v_exp_f32 v26, v26
    v_exp_f32 v27, v27
    v_exp_f32 v28, v28
    buffer_load_dwordx4 v[192:195], v252, s[56:59], s82 offen offset:0 sc1
    s_mov_b64 exec, s[70:71]
    buffer_load_dwordx4 v[196:199], v2, s[56:59], s82 offen offset:1024 sc1
    buffer_load_dwordx4 v[200:203], v2, s[56:59], s82 offen offset:1536 sc1
    s_mov_b64 exec, -1
    s_add_u32 s82, s82, 2048
    v_mfma_f32_32x32x16_bf16 v[40:55], v[204:207], v[12:15], 0
    v_exp_f32 v29, v29
    v_exp_f32 v30, v30
    v_exp_f32 v31, v31
    s_waitcnt vmcnt(14)
    s_waitcnt lgkmcnt(2)
    v_mfma_f32_32x32x16_bf16 v[64:79], v[56:59], v[244:247], v[64:79]
    v_exp_f32 v32, v32
    v_exp_f32 v33, v33
    v_exp_f32 v34, v34
    v_smfmac_f32_32x32x32_bf16 v[128:143], v[208:211], v[24:31], v3
    v_exp_f32 v35, v35
    v_exp_f32 v36, v36
    v_exp_f32 v37, v37
    v_mfma_f32_32x32x16_bf16 v[96:111], v[56:59], v[248:251], v[96:111]
    v_exp_f32 v38, v38
    v_exp_f32 v39, v39
    v_exp_f32 v40, v40
    v_exp_f32 v41, v41
    ds_read_b64_tr_b16 v[56:57], v5 offset:6144
    ds_read_b64_tr_b16 v[58:59], v5 offset:7168
    v_smfmac_f32_32x32x32_bf16 v[128:143], v[212:215], v[32:39], v3
    v_exp_f32 v42, v42
    v_exp_f32 v43, v43
    v_exp_f32 v44, v44
    v_mfma_f32_32x32x16_bf16 v[24:39], v[204:207], v[16:19], 0
    v_exp_f32 v45, v45
    v_exp_f32 v46, v46
    v_exp_f32 v47, v47
    s_waitcnt lgkmcnt(2)
    v_mfma_f32_32x32x16_bf16 v[112:127], v[60:63], v[248:251], v[112:127]
    v_exp_f32 v48, v48
    v_exp_f32 v49, v49
    v_exp_f32 v50, v50
    s_add_u32 m0, s84, 4096
    s_add_u32 s72, s85, 1179648
    buffer_load_dwordx4 v4, s[44:47], s72 offen offset:0 lds
    s_add_u32 s72, s72, 7168
    buffer_load_dwordx4 v4, s[44:47], s72 offen offset:1024 lds
    v_smfmac_f32_32x32x32_bf16 v[144:159], v[208:211], v[40:47], v3
    v_exp_f32 v51, v51
    v_exp_f32 v52, v52
    v_exp_f32 v53, v53
    v_mfma_f32_32x32x16_bf16 v[80:95], v[60:63], v[244:247], v[80:95]
    v_exp_f32 v54, v54
    v_exp_f32 v55, v55
    v_exp_f32 v24, v24
    v_exp_f32 v25, v25
    ds_read_b64_tr_b16 v[60:61], v6 offset:6144
    ds_read_b64_tr_b16 v[62:63], v6 offset:7168
    s_add_u32 s86, s86, 0x40000
    buffer_load_dwordx4 v[244:247], v1, s[56:59], s86 offen offset:0 sc1
    buffer_load_dwordx4 v[248:251], v1, s[56:59], s86 offen offset:1024 sc1
    v_smfmac_f32_32x32x32_bf16 v[144:159], v[212:215], v[48:55], v3
    v_exp_f32 v26, v26
    v_exp_f32 v27, v27
    v_exp_f32 v28, v28
    v_mfma_f32_32x32x16_bf16 v[40:55], v[204:207], v[20:23], 0
    v_exp_f32 v29, v29
    v_exp_f32 v30, v30
    v_exp_f32 v31, v31
    s_waitcnt vmcnt(11)
    s_waitcnt lgkmcnt(2)
    v_mfma_f32_32x32x16_bf16 v[64:79], v[56:59], v[228:231], v[64:79]
    v_exp_f32 v32, v32
    v_exp_f32 v33, v33
    v_exp_f32 v34, v34
    v_smfmac_f32_32x32x32_bf16 v[160:175], v[208:211], v[24:31], v3
    v_exp_f32 v35, v35
    v_exp_f32 v36, v36
    v_exp_f32 v37, v37
    v_mfma_f32_32x32x16_bf16 v[96:111], v[56:59], v[232:235], v[96:111]
    v_exp_f32 v38, v38
    v_exp_f32 v39, v39
    v_exp_f32 v40, v40
    v_exp_f32 v41, v41
    ds_read_b64_tr_b16 v[56:57], v5 offset:0
    ds_read_b64_tr_b16 v[58:59], v5 offset:1024
    v_smfmac_f32_32x32x32_bf16 v[160:175], v[212:215], v[32:39], v3
    v_exp_f32 v42, v42
    v_exp_f32 v43, v43
    v_exp_f32 v44, v44
    v_mfma_f32_32x32x16_bf16 v[24:39], v[216:219], v[8:11], 0
    v_exp_f32 v45, v45
    v_exp_f32 v46, v46
    v_exp_f32 v47, v47
    s_waitcnt lgkmcnt(2)
    v_mfma_f32_32x32x16_bf16 v[112:127], v[60:63], v[232:235], v[112:127]
    v_exp_f32 v48, v48
    v_exp_f32 v49, v49
    v_exp_f32 v50, v50
    s_add_u32 m0, s84, 6144
    s_add_u32 s72, s85, 1245184
    buffer_load_dwordx4 v4, s[44:47], s72 offen offset:0 lds
    s_add_u32 s72, s72, 7168
    buffer_load_dwordx4 v4, s[44:47], s72 offen offset:1024 lds
    v_smfmac_f32_32x32x32_bf16 v[176:191], v[208:211], v[40:47], v3
    v_exp_f32 v51, v51
    v_exp_f32 v52, v52
    v_exp_f32 v53, v53
    v_mfma_f32_32x32x16_bf16 v[80:95], v[60:63], v[228:231], v[80:95]
    v_exp_f32 v54, v54
    v_exp_f32 v55, v55
    v_exp_f32 v24, v24
    v_exp_f32 v25, v25
    ds_read_b64_tr_b16 v[60:61], v6 offset:0
    ds_read_b64_tr_b16 v[62:63], v6 offset:1024
    s_add_u32 s86, s86, 0x40000
    buffer_load_dwordx4 v[228:231], v1, s[56:59], s86 offen offset:0 sc1
    buffer_load_dwordx4 v[232:235], v1, s[56:59], s86 offen offset:1024 sc1
    v_smfmac_f32_32x32x32_bf16 v[176:191], v[212:215], v[48:55], v3
    v_exp_f32 v26, v26
    v_exp_f32 v27, v27
    v_exp_f32 v28, v28
    buffer_load_dwordx4 v[204:207], v252, s[56:59], s82 offen offset:0 sc1
    s_mov_b64 exec, s[70:71]
    buffer_load_dwordx4 v[208:211], v2, s[56:59], s82 offen offset:1024 sc1
    buffer_load_dwordx4 v[212:215], v2, s[56:59], s82 offen offset:1536 sc1
    s_mov_b64 exec, -1
    s_add_u32 s82, s82, 2048
    v_mfma_f32_32x32x16_bf16 v[40:55], v[216:219], v[12:15], 0
    v_exp_f32 v29, v29
    v_exp_f32 v30, v30
    v_exp_f32 v31, v31
    s_waitcnt vmcnt(14)
    s_waitcnt lgkmcnt(2)
    v_mfma_f32_32x32x16_bf16 v[64:79], v[56:59], v[236:239], v[64:79]
    v_exp_f32 v32, v32
    v_exp_f32 v33, v33
    v_exp_f32 v34, v34
    v_smfmac_f32_32x32x32_bf16 v[128:143], v[220:223], v[24:31], v3
    v_exp_f32 v35, v35
    v_exp_f32 v36, v36
    v_exp_f32 v37, v37
    v_mfma_f32_32x32x16_bf16 v[96:111], v[56:59], v[240:243], v[96:111]
    v_exp_f32 v38, v38
    v_exp_f32 v39, v39
    v_exp_f32 v40, v40
    v_exp_f32 v41, v41
    ds_read_b64_tr_b16 v[56:57], v5 offset:2048
    ds_read_b64_tr_b16 v[58:59], v5 offset:3072
    v_smfmac_f32_32x32x32_bf16 v[128:143], v[224:227], v[32:39], v3
    v_exp_f32 v42, v42
    v_exp_f32 v43, v43
    v_exp_f32 v44, v44
    v_mfma_f32_32x32x16_bf16 v[24:39], v[216:219], v[16:19], 0
    v_exp_f32 v45, v45
    v_exp_f32 v46, v46
    v_exp_f32 v47, v47
    s_waitcnt lgkmcnt(2)
    v_mfma_f32_32x32x16_bf16 v[112:127], v[60:63], v[240:243], v[112:127]
    v_exp_f32 v48, v48
    v_exp_f32 v49, v49
    v_exp_f32 v50, v50
    s_add_u32 m0, s84, 0
    s_add_u32 s72, s85, 1310720
    buffer_load_dwordx4 v4, s[44:47], s72 offen offset:0 lds
    s_add_u32 s72, s72, 7168
    buffer_load_dwordx4 v4, s[44:47], s72 offen offset:1024 lds
    v_smfmac_f32_32x32x32_bf16 v[144:159], v[220:223], v[40:47], v3
    v_exp_f32 v51, v51
    v_exp_f32 v52, v52
    v_exp_f32 v53, v53
    v_mfma_f32_32x32x16_bf16 v[80:95], v[60:63], v[236:239], v[80:95]
    v_exp_f32 v54, v54
    v_exp_f32 v55, v55
    v_exp_f32 v24, v24
    v_exp_f32 v25, v25
    ds_read_b64_tr_b16 v[60:61], v6 offset:2048
    ds_read_b64_tr_b16 v[62:63], v6 offset:3072
    s_add_u32 s86, s86, 0x40000
    buffer_load_dwordx4 v[236:239], v1, s[56:59], s86 offen offset:0 sc1
    buffer_load_dwordx4 v[240:243], v1, s[56:59], s86 offen offset:1024 sc1
    v_smfmac_f32_32x32x32_bf16 v[144:159], v[224:227], v[48:55], v3
    v_exp_f32 v26, v26
    v_exp_f32 v27, v27
    v_exp_f32 v28, v28
    v_mfma_f32_32x32x16_bf16 v[40:55], v[216:219], v[20:23], 0
    v_exp_f32 v29, v29
    v_exp_f32 v30, v30
    v_exp_f32 v31, v31
    s_waitcnt vmcnt(11)
    s_waitcnt lgkmcnt(2)
    v_mfma_f32_32x32x16_bf16 v[64:79], v[56:59], v[244:247], v[64:79]
    v_exp_f32 v32, v32
    v_exp_f32 v33, v33
    v_exp_f32 v34, v34
    v_smfmac_f32_32x32x32_bf16 v[160:175], v[220:223], v[24:31], v3
    v_exp_f32 v35, v35
    v_exp_f32 v36, v36
    v_exp_f32 v37, v37
    v_mfma_f32_32x32x16_bf16 v[96:111], v[56:59], v[248:251], v[96:111]
    v_exp_f32 v38, v38
    v_exp_f32 v39, v39
    v_exp_f32 v40, v40
    v_exp_f32 v41, v41
    ds_read_b64_tr_b16 v[56:57], v5 offset:4096
    ds_read_b64_tr_b16 v[58:59], v5 offset:5120
    v_smfmac_f32_32x32x32_bf16 v[160:175], v[224:227], v[32:39], v3
    v_exp_f32 v42, v42
    v_exp_f32 v43, v43
    v_exp_f32 v44, v44
    v_mfma_f32_32x32x16_bf16 v[24:39], v[192:195], v[8:11], 0
    v_exp_f32 v45, v45
    v_exp_f32 v46, v46
    v_exp_f32 v47, v47
    s_waitcnt lgkmcnt(2)
    v_mfma_f32_32x32x16_bf16 v[112:127], v[60:63], v[248:251], v[112:127]
    v_exp_f32 v48, v48
    v_exp_f32 v49, v49
    v_exp_f32 v50, v50
    s_add_u32 m0, s84, 2048
    s_add_u32 s72, s85, 1376256
    buffer_load_dwordx4 v4, s[44:47], s72 offen offset:0 lds
    s_add_u32 s72, s72, 7168
    buffer_load_dwordx4 v4, s[44:47], s72 offen offset:1024 lds
    v_smfmac_f32_32x32x32_bf16 v[176:191], v[220:223], v[40:47], v3
    v_exp_f32 v51, v51
    v_exp_f32 v52, v52
    v_exp_f32 v53, v53
    v_mfma_f32_32x32x16_bf16 v[80:95], v[60:63], v[244:247], v[80:95]
    v_exp_f32 v54, v54
    v_exp_f32 v55, v55
    v_exp_f32 v24, v24
    v_exp_f32 v25, v25
    ds_read_b64_tr_b16 v[60:61], v6 offset:4096
    ds_read_b64_tr_b16 v[62:63], v6 offset:5120
    s_add_u32 s86, s86, 0x40000
    buffer_load_dwordx4 v[244:247], v1, s[56:59], s86 offen offset:0 sc1
    buffer_load_dwordx4 v[248:251], v1, s[56:59], s86 offen offset:1024 sc1
    v_smfmac_f32_32x32x32_bf16 v[176:191], v[224:227], v[48:55], v3
    v_exp_f32 v26, v26
    v_exp_f32 v27, v27
    v_exp_f32 v28, v28
    buffer_load_dwordx4 v[216:219], v252, s[56:59], s82 offen offset:0 sc1
    s_mov_b64 exec, s[70:71]
    buffer_load_dwordx4 v[220:223], v2, s[56:59], s82 offen offset:1024 sc1
    buffer_load_dwordx4 v[224:227], v2, s[56:59], s82 offen offset:1536 sc1
    s_mov_b64 exec, -1
    s_add_u32 s82, s82, 2048
    v_mfma_f32_32x32x16_bf16 v[40:55], v[192:195], v[12:15], 0
    v_exp_f32 v29, v29
    v_exp_f32 v30, v30
    v_exp_f32 v31, v31
    s_waitcnt vmcnt(14)
    s_waitcnt lgkmcnt(2)
    v_mfma_f32_32x32x16_bf16 v[64:79], v[56:59], v[228:231], v[64:79]
    v_exp_f32 v32, v32
    v_exp_f32 v33, v33
    v_exp_f32 v34, v34
    v_smfmac_f32_32x32x32_bf16 v[128:143], v[196:199], v[24:31], v3
    v_exp_f32 v35, v35
    v_exp_f32 v36, v36
    v_exp_f32 v37, v37
    v_mfma_f32_32x32x16_bf16 v[96:111], v[56:59], v[232:235], v[96:111]
    v_exp_f32 v38, v38
    v_exp_f32 v39, v39
    v_exp_f32 v40, v40
    v_exp_f32 v41, v41
    ds_read_b64_tr_b16 v[56:57], v5 offset:6144
    ds_read_b64_tr_b16 v[58:59], v5 offset:7168
    v_smfmac_f32_32x32x32_bf16 v[128:143], v[200:203], v[32:39], v3
    v_exp_f32 v42, v42
    v_exp_f32 v43, v43
    v_exp_f32 v44, v44
    v_mfma_f32_32x32x16_bf16 v[24:39], v[192:195], v[16:19], 0
    v_exp_f32 v45, v45
    v_exp_f32 v46, v46
    v_exp_f32 v47, v47
    s_waitcnt lgkmcnt(2)
    v_mfma_f32_32x32x16_bf16 v[112:127], v[60:63], v[232:235], v[112:127]
    v_exp_f32 v48, v48
    v_exp_f32 v49, v49
    v_exp_f32 v50, v50
    v_smfmac_f32_32x32x32_bf16 v[144:159], v[196:199], v[40:47], v3
    v_exp_f32 v51, v51
    v_exp_f32 v52, v52
    v_exp_f32 v53, v53
    v_mfma_f32_32x32x16_bf16 v[80:95], v[60:63], v[228:231], v[80:95]
    v_exp_f32 v54, v54
    v_exp_f32 v55, v55
    v_exp_f32 v24, v24
    v_exp_f32 v25, v25
    ds_read_b64_tr_b16 v[60:61], v6 offset:6144
    ds_read_b64_tr_b16 v[62:63], v6 offset:7168
    s_add_u32 s86, s86, 0x40000
    buffer_load_dwordx4 v[228:231], v1, s[56:59], s86 offen offset:0 sc1
    buffer_load_dwordx4 v[232:235], v1, s[56:59], s86 offen offset:1024 sc1
    v_smfmac_f32_32x32x32_bf16 v[144:159], v[200:203], v[48:55], v3
    v_exp_f32 v26, v26
    v_exp_f32 v27, v27
    v_exp_f32 v28, v28
    v_mfma_f32_32x32x16_bf16 v[40:55], v[192:195], v[20:23], 0
    v_exp_f32 v29, v29
    v_exp_f32 v30, v30
    v_exp_f32 v31, v31
    s_waitcnt vmcnt(9)
    s_waitcnt lgkmcnt(2)
    v_mfma_f32_32x32x16_bf16 v[64:79], v[56:59], v[236:239], v[64:79]
    v_exp_f32 v32, v32
    v_exp_f32 v33, v33
    v_exp_f32 v34, v34
    v_smfmac_f32_32x32x32_bf16 v[160:175], v[196:199], v[24:31], v3
    v_exp_f32 v35, v35
    v_exp_f32 v36, v36
    v_exp_f32 v37, v37
    v_mfma_f32_32x32x16_bf16 v[96:111], v[56:59], v[240:243], v[96:111]
    v_exp_f32 v38, v38
    v_exp_f32 v39, v39
    v_exp_f32 v40, v40
    v_exp_f32 v41, v41
    ds_read_b64_tr_b16 v[56:57], v5 offset:0
    ds_read_b64_tr_b16 v[58:59], v5 offset:1024
    v_smfmac_f32_32x32x32_bf16 v[160:175], v[200:203], v[32:39], v3
    v_exp_f32 v42, v42
    v_exp_f32 v43, v43
    v_exp_f32 v44, v44
    v_mfma_f32_32x32x16_bf16 v[24:39], v[204:207], v[8:11], 0
    v_exp_f32 v45, v45
    v_exp_f32 v46, v46
    v_exp_f32 v47, v47
    s_waitcnt lgkmcnt(2)
    v_mfma_f32_32x32x16_bf16 v[112:127], v[60:63], v[240:243], v[112:127]
    v_exp_f32 v48, v48
    v_exp_f32 v49, v49
    v_exp_f32 v50, v50
    v_smfmac_f32_32x32x32_bf16 v[176:191], v[196:199], v[40:47], v3
    v_exp_f32 v51, v51
    v_exp_f32 v52, v52
    v_exp_f32 v53, v53
    v_mfma_f32_32x32x16_bf16 v[80:95], v[60:63], v[236:239], v[80:95]
    v_exp_f32 v54, v54
    v_exp_f32 v55, v55
    v_exp_f32 v24, v24
    v_exp_f32 v25, v25
    ds_read_b64_tr_b16 v[60:61], v6 offset:0
    ds_read_b64_tr_b16 v[62:63], v6 offset:1024
    v_smfmac_f32_32x32x32_bf16 v[176:191], v[200:203], v[48:55], v3
    v_exp_f32 v26, v26
    v_exp_f32 v27, v27
    v_exp_f32 v28, v28
    buffer_load_dwordx4 v[192:195], v252, s[56:59], s82 offen offset:0 sc1
    s_mov_b64 exec, s[70:71]
    buffer_load_dwordx4 v[196:199], v2, s[56:59], s82 offen offset:1024 sc1
    buffer_load_dwordx4 v[200:203], v2, s[56:59], s82 offen offset:1536 sc1
    s_mov_b64 exec, -1
    s_add_u32 s82, s82, 2048
    v_mfma_f32_32x32x16_bf16 v[40:55], v[204:207], v[12:15], 0
    v_exp_f32 v29, v29
    v_exp_f32 v30, v30
    v_exp_f32 v31, v31
    s_waitcnt vmcnt(8)
    s_waitcnt lgkmcnt(2)
    v_mfma_f32_32x32x16_bf16 v[64:79], v[56:59], v[244:247], v[64:79]
    v_exp_f32 v32, v32
    v_exp_f32 v33, v33
    v_exp_f32 v34, v34
    v_smfmac_f32_32x32x32_bf16 v[128:143], v[208:211], v[24:31], v3
    v_exp_f32 v35, v35
    v_exp_f32 v36, v36
    v_exp_f32 v37, v37
    v_mfma_f32_32x32x16_bf16 v[96:111], v[56:59], v[248:251], v[96:111]
    v_exp_f32 v38, v38
    v_exp_f32 v39, v39
    v_exp_f32 v40, v40
    v_exp_f32 v41, v41
    ds_read_b64_tr_b16 v[56:57], v5 offset:2048
    ds_read_b64_tr_b16 v[58:59], v5 offset:3072
    v_smfmac_f32_32x32x32_bf16 v[128:143], v[212:215], v[32:39], v3
    v_exp_f32 v42, v42
    v_exp_f32 v43, v43
    v_exp_f32 v44, v44
    v_mfma_f32_32x32x16_bf16 v[24:39], v[204:207], v[16:19], 0
    v_exp_f32 v45, v45
    v_exp_f32 v46, v46
    v_exp_f32 v47, v47
    s_waitcnt lgkmcnt(2)
    v_mfma_f32_32x32x16_bf16 v[112:127], v[60:63], v[248:251], v[112:127]
    v_exp_f32 v48, v48
    v_exp_f32 v49, v49
    v_exp_f32 v50, v50
    v_smfmac_f32_32x32x32_bf16 v[144:159], v[208:211], v[40:47], v3
    v_exp_f32 v51, v51
    v_exp_f32 v52, v52
    v_exp_f32 v53, v53
    v_mfma_f32_32x32x16_bf16 v[80:95], v[60:63], v[244:247], v[80:95]
    v_exp_f32 v54, v54
    v_exp_f32 v55, v55
    v_exp_f32 v24, v24
    v_exp_f32 v25, v25
    ds_read_b64_tr_b16 v[60:61], v6 offset:2048
    ds_read_b64_tr_b16 v[62:63], v6 offset:3072
    v_smfmac_f32_32x32x32_bf16 v[144:159], v[212:215], v[48:55], v3
    v_exp_f32 v26, v26
    v_exp_f32 v27, v27
    v_exp_f32 v28, v28
    v_mfma_f32_32x32x16_bf16 v[40:55], v[204:207], v[20:23], 0
    v_exp_f32 v29, v29
    v_exp_f32 v30, v30
    v_exp_f32 v31, v31
    s_waitcnt vmcnt(3)
    s_waitcnt lgkmcnt(2)
    v_mfma_f32_32x32x16_bf16 v[64:79], v[56:59], v[228:231], v[64:79]
    v_exp_f32 v32, v32
    v_exp_f32 v33, v33
    v_exp_f32 v34, v34
    v_smfmac_f32_32x32x32_bf16 v[160:175], v[208:211], v[24:31], v3
    v_exp_f32 v35, v35
    v_exp_f32 v36, v36
    v_exp_f32 v37, v37
    v_mfma_f32_32x32x16_bf16 v[96:111], v[56:59], v[232:235], v[96:111]
    v_exp_f32 v38, v38
    v_exp_f32 v39, v39
    v_exp_f32 v40, v40
    v_exp_f32 v41, v41
    v_smfmac_f32_32x32x32_bf16 v[160:175], v[212:215], v[32:39], v3
    v_exp_f32 v42, v42
    v_exp_f32 v43, v43
    v_exp_f32 v44, v44
    v_mfma_f32_32x32x16_bf16 v[24:39], v[216:219], v[8:11], 0
    v_exp_f32 v45, v45
    v_exp_f32 v46, v46
    v_exp_f32 v47, v47
    s_waitcnt lgkmcnt(0)
    v_mfma_f32_32x32x16_bf16 v[112:127], v[60:63], v[232:235], v[112:127]
    v_exp_f32 v48, v48
    v_exp_f32 v49, v49
    v_exp_f32 v50, v50
    v_smfmac_f32_32x32x32_bf16 v[176:191], v[208:211], v[40:47], v3
    v_exp_f32 v51, v51
    v_exp_f32 v52, v52
    v_exp_f32 v53, v53
    v_mfma_f32_32x32x16_bf16 v[80:95], v[60:63], v[228:231], v[80:95]
    v_exp_f32 v54, v54
    v_exp_f32 v55, v55
    v_exp_f32 v24, v24
    v_exp_f32 v25, v25
    v_smfmac_f32_32x32x32_bf16 v[176:191], v[212:215], v[48:55], v3
    v_exp_f32 v26, v26
    v_exp_f32 v27, v27
    v_exp_f32 v28, v28
    v_mfma_f32_32x32x16_bf16 v[40:55], v[216:219], v[12:15], 0
    v_exp_f32 v29, v29
    v_exp_f32 v30, v30
    v_and_b32 v4, 31, v0
    v_mul_u32_u24 v4, 144, v4
    v_lshrrev_b32 v5, 5, v0
    v_lshl_add_u32 v4, v5, 4, v4
    v_add_u32 v4, s84, v4
    v_exp_f32 v31, v31
    v_cvt_pk_bf16_f32 v64, v64, v65
    v_cvt_pk_bf16_f32 v65, v66, v67
    v_cvt_pk_bf16_f32 v66, v68, v69
    v_cvt_pk_bf16_f32 v67, v70, v71
    v_cvt_pk_bf16_f32 v68, v72, v73
    v_cvt_pk_bf16_f32 v69, v74, v75
    v_cvt_pk_bf16_f32 v70, v76, v77
    v_cvt_pk_bf16_f32 v71, v78, v79
    ds_write_b128 v4, v[64:67] offset:0
    ds_write_b128 v4, v[68:71] offset:32
    v_exp_f32 v32, v32
    v_exp_f32 v33, v33
    s_and_b32 s73, s60, 1
    s_lshl_b32 s73, s73, 9
    s_sub_u32 s76, s95, s73
    s_and_b32 s74, s60, 3
    s_lshr_b32 s75, s60, 2
    v_lshrrev_b32 v14, 3, v0
    v_and_b32 v7, 7, v0
    v_lshlrev_b32 v7, 4, v7
    v_lshl_add_u32 v14, v14, 10, v7
    s_lshl3_add_u32 s78, s66, s60
    s_lshl_b32 s78, s78, 13
    s_lshl_b32 s79, s67, 7
    s_add_u32 s78, s78, s79
    buffer_load_dwordx4 v[60:63], v7, s[48:51], s79 offen offset:0
    buffer_load_dwordx4 v[56:59], v14, s[24:27], s78 offen offset:0
    v_exp_f32 v34, v34
    v_smfmac_f32_32x32x32_bf16 v[128:143], v[220:223], v[24:31], v3
    v_exp_f32 v35, v35
    v_lshlrev_b32 v8, 2, v0
    v_add_u32 v9, s99, v1
    v_add_u32 v10, s99, v8
    v_bfe_u32 v11, v0, 4, 1
    v_lshl_add_u32 v11, v11, 10, v2
    v_exp_f32 v36, v36
    v_exp_f32 v37, v37
    v_exp_f32 v38, v38
    v_exp_f32 v39, v39
    v_exp_f32 v40, v40
    v_exp_f32 v41, v41
    v_smfmac_f32_32x32x32_bf16 v[128:143], v[224:227], v[32:39], v3
    v_exp_f32 v42, v42
    v_exp_f32 v43, v43
    v_exp_f32 v44, v44
    v_mfma_f32_32x32x16_bf16 v[24:39], v[216:219], v[16:19], 0
    v_exp_f32 v45, v45
    v_exp_f32 v46, v46
    v_exp_f32 v47, v47
    v_cvt_pk_bf16_f32 v96, v96, v97
    v_cvt_pk_bf16_f32 v97, v98, v99
    v_cvt_pk_bf16_f32 v98, v100, v101
    v_cvt_pk_bf16_f32 v99, v102, v103
    v_cvt_pk_bf16_f32 v100, v104, v105
    v_cvt_pk_bf16_f32 v101, v106, v107
    v_cvt_pk_bf16_f32 v102, v108, v109
    v_cvt_pk_bf16_f32 v103, v110, v111
    ds_write_b128 v4, v[96:99] offset:4608
    ds_write_b128 v4, v[100:103] offset:4640
    v_exp_f32 v48, v48
    v_exp_f32 v49, v49
    v_exp_f32 v50, v50
    v_smfmac_f32_32x32x32_bf16 v[144:159], v[220:223], v[40:47], v3
    v_exp_f32 v51, v51
    v_exp_f32 v52, v52
    v_add_u32 v12, s96, v1
    v_add_u32 v13, s96, v8
    ds_write_b128 v12, v[128:131] offset:0
    ds_write_b128 v12, v[132:135] offset:1024
    ds_write_b32 v13, v136 offset:2048
    v_exp_f32 v53, v53
    v_exp_f32 v54, v54
    v_exp_f32 v55, v55
    v_exp_f32 v24, v24
    v_exp_f32 v25, v25
    v_smfmac_f32_32x32x32_bf16 v[144:159], v[224:227], v[48:55], v3
    v_exp_f32 v26, v26
    v_exp_f32 v27, v27
    v_exp_f32 v28, v28
    v_mfma_f32_32x32x16_bf16 v[40:55], v[216:219], v[20:23], 0
    v_exp_f32 v29, v29
    v_exp_f32 v30, v30
    v_exp_f32 v31, v31
    v_cvt_pk_bf16_f32 v112, v112, v113
    v_cvt_pk_bf16_f32 v113, v114, v115
    v_cvt_pk_bf16_f32 v114, v116, v117
    v_cvt_pk_bf16_f32 v115, v118, v119
    v_cvt_pk_bf16_f32 v116, v120, v121
    v_cvt_pk_bf16_f32 v117, v122, v123
    v_cvt_pk_bf16_f32 v118, v124, v125
    v_cvt_pk_bf16_f32 v119, v126, v127
    ds_write_b128 v4, v[112:115] offset:4672
    ds_write_b128 v4, v[116:119] offset:4704
    v_exp_f32 v32, v32
    v_exp_f32 v33, v33
    v_exp_f32 v34, v34
    v_smfmac_f32_32x32x32_bf16 v[160:175], v[220:223], v[24:31], v3
    v_exp_f32 v35, v35
    v_exp_f32 v36, v36
    v_add_u32 v12, s97, v1
    v_add_u32 v13, s97, v8
    ds_write_b128 v12, v[144:147] offset:2304
    ds_write_b128 v12, v[148:151] offset:3328
    ds_write_b32 v13, v152 offset:4352
    v_exp_f32 v37, v37
    v_exp_f32 v38, v38
    v_exp_f32 v39, v39
    v_exp_f32 v40, v40
    v_exp_f32 v41, v41
    v_smfmac_f32_32x32x32_bf16 v[160:175], v[224:227], v[32:39], v3
    v_exp_f32 v42, v42
    v_exp_f32 v43, v43
    v_exp_f32 v44, v44
    s_waitcnt vmcnt(2)
    v_mfma_f32_32x32x16_bf16 v[24:39], v[192:195], v[16:19], 0
    v_exp_f32 v45, v45
    v_exp_f32 v46, v46
    v_exp_f32 v47, v47
    v_cvt_pk_bf16_f32 v80, v80, v81
    v_cvt_pk_bf16_f32 v81, v82, v83
    v_cvt_pk_bf16_f32 v82, v84, v85
    v_cvt_pk_bf16_f32 v83, v86, v87
    v_cvt_pk_bf16_f32 v84, v88, v89
    v_cvt_pk_bf16_f32 v85, v90, v91
    v_cvt_pk_bf16_f32 v86, v92, v93
    v_cvt_pk_bf16_f32 v87, v94, v95
    ds_write_b128 v4, v[80:83] offset:64
    ds_write_b128 v4, v[84:87] offset:96
    v_exp_f32 v48, v48
    v_exp_f32 v49, v49
    v_exp_f32 v50, v50
    v_smfmac_f32_32x32x32_bf16 v[176:191], v[220:223], v[40:47], v3
    v_exp_f32 v51, v51
    v_exp_f32 v52, v52
    v_exp_f32 v53, v53
    v_exp_f32 v54, v54
    v_exp_f32 v55, v55
    v_exp_f32 v24, v24
    v_exp_f32 v25, v25
    v_smfmac_f32_32x32x32_bf16 v[176:191], v[224:227], v[48:55], v3
    v_exp_f32 v26, v26
    v_exp_f32 v27, v27
    v_exp_f32 v28, v28
    v_mfma_f32_32x32x16_bf16 v[40:55], v[192:195], v[20:23], 0
    v_exp_f32 v29, v29
    v_exp_f32 v30, v30
    v_exp_f32 v31, v31
    v_exp_f32 v32, v32
    v_exp_f32 v33, v33
    v_exp_f32 v34, v34
    v_smfmac_f32_32x32x32_bf16 v[160:175], v[196:199], v[24:31], v3
    v_exp_f32 v35, v35
    v_exp_f32 v36, v36
    v_exp_f32 v37, v37
    v_exp_f32 v38, v38
    v_exp_f32 v39, v39
    v_exp_f32 v40, v40
    s_setprio 0
    v_exp_f32 v41, v41
    v_smfmac_f32_32x32x32_bf16 v[160:175], v[200:203], v[32:39], v3
    v_exp_f32 v42, v42
    v_exp_f32 v43, v43
    v_exp_f32 v44, v44
    v_exp_f32 v45, v45
    v_exp_f32 v46, v46
    v_exp_f32 v47, v47
    v_exp_f32 v48, v48
    v_exp_f32 v49, v49
    v_exp_f32 v50, v50
    v_smfmac_f32_32x32x32_bf16 v[176:191], v[196:199], v[40:47], v3
    v_exp_f32 v51, v51
    v_exp_f32 v52, v52
    v_add_u32 v12, s98, v1
    v_add_u32 v13, s98, v8
    ds_write_b128 v12, v[160:163] offset:4608
    ds_write_b128 v12, v[164:167] offset:5632
    ds_write_b32 v13, v168 offset:6656
    v_exp_f32 v53, v53
    v_exp_f32 v54, v54
    v_exp_f32 v55, v55
    s_nop 1
    v_smfmac_f32_32x32x32_bf16 v[176:191], v[200:203], v[48:55], v3
    s_waitcnt vmcnt(0)
    s_branch L_att_done
L_loader:
    s_load_dwordx2 s[28:29], s[0:1], 8
    s_load_dwordx2 s[56:57], s[0:1], 80
    s_load_dwordx2 s[36:37], s[0:1], 32
    s_load_dwordx2 s[40:41], s[0:1], 40
    s_load_dwordx2 s[32:33], s[0:1], 16
    s_load_dwordx2 s[44:45], s[0:1], 48
    s_load_dwordx2 s[48:49], s[0:1], 56
    s_load_dwordx2 s[52:53], s[0:1], 64
    s_mov_b32 s30, 1572864
    s_mov_b32 s31, 0x20000
    s_bfe_u32 s72, s2, 0x20003
    s_and_b32 s73, s2, 1
    s_lshl2_add_u32 s61, s73, s72
    s_and_b32 s74, s60, 3
    s_lshl_b32 s72, s61, 7
    s_mul_i32 s85, s74, 49152
    s_add_u32 s85, s85, s72
    s_mul_i32 s87, s74, 6144
    s_add_u32 s87, s87, 65536
    v_lshrrev_b32 v4, 3, v0
    v_bfe_u32 v6, v4, 1, 1
    v_lshlrev_b32 v6, 2, v6
    v_xor_b32 v6, v6, v5
    v_lshlrev_b32 v6, 4, v6
    v_mul_u32_u24 v13, 3072, v4
    v_add_u32 v13, v13, v6
    v_xor_b32 v33, 16, v13
    s_waitcnt lgkmcnt(0)
    s_barrier
    s_xor_b32 s73, s67, 2
    s_mul_i32 s73, s73, 196608
    s_add_u32 s73, s73, s85
    s_add_u32 m0, s87, 49152
    s_add_u32 s72, s73, 0
    buffer_load_dwordx4 v13, s[28:31], s72 offen offset:0 lds
    s_add_u32 m0, s87, 51200
    s_add_u32 s72, s73, 1024
    buffer_load_dwordx4 v13, s[28:31], s72 offen offset:0 lds
    s_add_u32 m0, s87, 53248
    s_add_u32 s72, s73, 2048
    buffer_load_dwordx4 v13, s[28:31], s72 offen offset:0 lds
    s_add_u32 m0, s87, 50176
    s_add_u32 s72, s73, 24576
    buffer_load_dwordx4 v33, s[28:31], s72 offen offset:0 lds
    s_add_u32 m0, s87, 52224
    s_add_u32 s72, s73, 25600
    buffer_load_dwordx4 v33, s[28:31], s72 offen offset:0 lds
    s_add_u32 m0, s87, 54272
    s_add_u32 s72, s73, 26624
    buffer_load_dwordx4 v33, s[28:31], s72 offen offset:0 lds
    s_xor_b32 s73, s67, 3
    s_mul_i32 s73, s73, 196608
    s_add_u32 s73, s73, s85
    s_add_u32 m0, s87, 73728
    s_add_u32 s72, s73, 0
    buffer_load_dwordx4 v13, s[28:31], s72 offen offset:0 lds
    s_add_u32 m0, s87, 75776
    s_add_u32 s72, s73, 1024
    buffer_load_dwordx4 v13, s[28:31], s72 offen offset:0 lds
    s_add_u32 m0, s87, 77824
    s_add_u32 s72, s73, 2048
    buffer_load_dwordx4 v13, s[28:31], s72 offen offset:0 lds
    s_add_u32 m0, s87, 74752
    s_add_u32 s72, s73, 24576
    buffer_load_dwordx4 v33, s[28:31], s72 offen offset:0 lds
    s_add_u32 m0, s87, 76800
    s_add_u32 s72, s73, 25600
    buffer_load_dwordx4 v33, s[28:31], s72 offen offset:0 lds
    s_add_u32 m0, s87, 78848
    s_add_u32 s72, s73, 26624
    buffer_load_dwordx4 v33, s[28:31], s72 offen offset:0 lds
    s_mov_b32 s38, 1409024
    s_mov_b32 s39, 0x20000
    s_and_b32 s73, s60, 3
    s_lshl1_add_u32 s100, s2, s73
    s_mul_i32 s100, s100, 2816
    s_bitcmp1_b32 s2, 0
    s_cselect_b32 s100, 0x40000000, s100
    v_min_u32 v31, 21, v0
    v_lshlrev_b32 v31, 7, v31
    s_barrier
    buffer_load_dword v32, v31, s[36:39], s100 offen offset:0
    s_waitcnt vmcnt(7)
    s_barrier
    s_xor_b32 s73, s67, 4
    s_mul_i32 s73, s73, 196608
    s_add_u32 s73, s73, s85
    s_add_u32 m0, s87, 0
    s_add_u32 s72, s73, 0
    buffer_load_dwordx4 v13, s[28:31], s72 offen offset:0 lds
    s_add_u32 m0, s87, 2048
    s_add_u32 s72, s73, 1024
    buffer_load_dwordx4 v13, s[28:31], s72 offen offset:0 lds
    s_add_u32 m0, s87, 4096
    s_add_u32 s72, s73, 2048
    buffer_load_dwordx4 v13, s[28:31], s72 offen offset:0 lds
    s_add_u32 m0, s87, 1024
    s_add_u32 s72, s73, 24576
    buffer_load_dwordx4 v33, s[28:31], s72 offen offset:0 lds
    s_add_u32 m0, s87, 3072
    s_add_u32 s72, s73, 25600
    buffer_load_dwordx4 v33, s[28:31], s72 offen offset:0 lds
    s_add_u32 m0, s87, 5120
    s_add_u32 s72, s73, 26624
    buffer_load_dwordx4 v33, s[28:31], s72 offen offset:0 lds
    s_waitcnt vmcnt(7)
    s_barrier
    s_xor_b32 s73, s67, 5
    s_mul_i32 s73, s73, 196608
    s_add_u32 s73, s73, s85
    s_add_u32 m0, s87, 24576
    s_add_u32 s72, s73, 0
    buffer_load_dwordx4 v13, s[28:31], s72 offen offset:0 lds
    s_add_u32 m0, s87, 26624
    s_add_u32 s72, s73, 1024
    buffer_load_dwordx4 v13, s[28:31], s72 offen offset:0 lds
    s_add_u32 m0, s87, 28672
    s_add_u32 s72, s73, 2048
    buffer_load_dwordx4 v13, s[28:31], s72 offen offset:0 lds
    s_add_u32 m0, s87, 25600
    s_add_u32 s72, s73, 24576
    buffer_load_dwordx4 v33, s[28:31], s72 offen offset:0 lds
    s_add_u32 m0, s87, 27648
    s_add_u32 s72, s73, 25600
    buffer_load_dwordx4 v33, s[28:31], s72 offen offset:0 lds
    s_add_u32 m0, s87, 29696
    s_add_u32 s72, s73, 26624
    buffer_load_dwordx4 v33, s[28:31], s72 offen offset:0 lds
    s_load_dword s68, s[56:57], 0
    s_mov_b32 s58, 12976128
    s_mov_b32 s59, 0x20000
    s_mov_b32 s42, 2752
    s_mov_b32 s43, 0x20000
    s_mov_b32 s50, 1024
    s_mov_b32 s51, 0x20000
    s_mov_b32 s54, 2097152
    s_mov_b32 s55, 0x20000
    s_bfe_u32 s72, s2, 0x20003
    s_and_b32 s73, s2, 7
    s_lshl2_add_u32 s66, s73, s72
    s_and_b32 s72, s72, 1
    s_and_b32 s64, s2, 6
    s_add_u32 s72, s72, s64
    s_and_b32 s64, s2, 1
    s_lshl3_add_u32 s64, s64, s72
    s_lshr_b32 s65, s2, 4
    s_mul_i32 s69, s61, 6
    s_mul_i32 s73, s61, 5
    s_add_u32 s73, s73, 3
    s_min_u32 s69, s69, s73
    s_mov_b32 s70, 0xffff
    s_mov_b32 s71, 0xffff
    v_lshlrev_b32 v1, 4, v0
    v_and_b32 v2, 15, v0
    v_lshrrev_b32 v3, 5, v0
    v_lshl_add_u32 v2, v3, 4, v2
    v_lshlrev_b32 v2, 4, v2
    v_mul_u32_u24 v56, 2752, v4
    v_add_u32 v56, v56, v6
    s_lshr_b32 s72, 0xf8, s61
    s_and_b32 s72, s72, 1
    s_lshl_b32 s72, s72, 23
    v_and_b32 v57, 64, v6
    v_mad_u32_u24 v57, v57, s72, v56
    v_xor_b32 v58, 16, v56
    v_xor_b32 v59, 16, v57
    s_lshr_b32 s79, s64, 1
    s_lshl_b32 s79, s79, 10
    s_add_u32 s79, s79, 4608
    s_and_b32 s73, s60, 3
    s_lshl_b32 s72, s69, 6
    s_mul_i32 s80, s73, 44032
    s_add_u32 s80, s80, s72
    v_mov_b32 v3, 0xdddddddd
    s_waitcnt vmcnt(6)
    s_barrier
    s_xor_b32 s73, s67, 6
    s_mul_i32 s73, s73, 196608
    s_add_u32 s73, s73, s85
    s_add_u32 m0, s87, 49152
    s_add_u32 s72, s73, 0
    buffer_load_dwordx4 v13, s[28:31], s72 offen offset:0 lds
    s_add_u32 m0, s87, 51200
    s_add_u32 s72, s73, 1024
    buffer_load_dwordx4 v13, s[28:31], s72 offen offset:0 lds
    s_add_u32 m0, s87, 53248
    s_add_u32 s72, s73, 2048
    buffer_load_dwordx4 v13, s[28:31], s72 offen offset:0 lds
    s_add_u32 m0, s87, 50176
    s_add_u32 s72, s73, 24576
    buffer_load_dwordx4 v33, s[28:31], s72 offen offset:0 lds
    s_add_u32 m0, s87, 52224
    s_add_u32 s72, s73, 25600
    buffer_load_dwordx4 v33, s[28:31], s72 offen offset:0 lds
    s_add_u32 m0, s87, 54272
    s_add_u32 s72, s73, 26624
    buffer_load_dwordx4 v33, s[28:31], s72 offen offset:0 lds
    s_waitcnt vmcnt(6)
    s_barrier
    s_xor_b32 s73, s67, 7
    s_mul_i32 s73, s73, 196608
    s_add_u32 s73, s73, s85
    s_add_u32 m0, s87, 73728
    s_add_u32 s72, s73, 0
    buffer_load_dwordx4 v13, s[28:31], s72 offen offset:0 lds
    s_add_u32 m0, s87, 75776
    s_add_u32 s72, s73, 1024
    buffer_load_dwordx4 v13, s[28:31], s72 offen offset:0 lds
    s_add_u32 m0, s87, 77824
    s_add_u32 s72, s73, 2048
    buffer_load_dwordx4 v13, s[28:31], s72 offen offset:0 lds
    s_add_u32 m0, s87, 74752
    s_add_u32 s72, s73, 24576
    buffer_load_dwordx4 v33, s[28:31], s72 offen offset:0 lds
    s_add_u32 m0, s87, 76800
    s_add_u32 s72, s73, 25600
    buffer_load_dwordx4 v33, s[28:31], s72 offen offset:0 lds
    s_add_u32 m0, s87, 78848
    s_add_u32 s72, s73, 26624
    buffer_load_dwordx4 v33, s[28:31], s72 offen offset:0 lds
    s_waitcnt vmcnt(6)
    s_barrier
    s_xor_b32 s73, s67, 0
    s_mul_i32 s73, s73, 176128
    s_add_u32 s73, s73, s80
    s_add_u32 m0, s87, 0
    s_add_u32 s72, s73, 0
    buffer_load_dwordx4 v56, s[36:39], s72 offen offset:0 lds
    s_add_u32 m0, s87, 2048
    s_add_u32 s72, s73, 128
    buffer_load_dwordx4 v56, s[36:39], s72 offen offset:0 lds
    s_add_u32 m0, s87, 4096
    s_add_u32 s72, s73, 256
    buffer_load_dwordx4 v57, s[36:39], s72 offen offset:0 lds
    s_add_u32 m0, s87, 1024
    s_add_u32 s72, s73, 22016
    buffer_load_dwordx4 v58, s[36:39], s72 offen offset:0 lds
    s_add_u32 m0, s87, 3072
    s_add_u32 s72, s73, 22144
    buffer_load_dwordx4 v58, s[36:39], s72 offen offset:0 lds
    s_add_u32 m0, s87, 5120
    s_add_u32 s72, s73, 22272
    buffer_load_dwordx4 v59, s[36:39], s72 offen offset:0 lds
    s_waitcnt vmcnt(6)
    s_barrier
    s_xor_b32 s73, s67, 1
    s_mul_i32 s73, s73, 176128
    s_add_u32 s73, s73, s80
    s_add_u32 m0, s87, 24576
    s_add_u32 s72, s73, 0
    buffer_load_dwordx4 v56, s[36:39], s72 offen offset:0 lds
    s_add_u32 m0, s87, 26624
    s_add_u32 s72, s73, 128
    buffer_load_dwordx4 v56, s[36:39], s72 offen offset:0 lds
    s_add_u32 m0, s87, 28672
    s_add_u32 s72, s73, 256
    buffer_load_dwordx4 v57, s[36:39], s72 offen offset:0 lds
    s_add_u32 m0, s87, 25600
    s_add_u32 s72, s73, 22016
    buffer_load_dwordx4 v58, s[36:39], s72 offen offset:0 lds
    s_add_u32 m0, s87, 27648
    s_add_u32 s72, s73, 22144
    buffer_load_dwordx4 v58, s[36:39], s72 offen offset:0 lds
    s_add_u32 m0, s87, 29696
    s_add_u32 s72, s73, 22272
    buffer_load_dwordx4 v59, s[36:39], s72 offen offset:0 lds
    s_and_b32 s74, s60, 1
    s_lshr_b32 s75, s60, 1
    s_lshl1_add_u32 s72, s64, s74
    s_lshl_b32 s83, s72, 17
    s_add_u32 s83, s83, 3145728
    s_and_b32 s73, s75, 1
    s_lshl_b32 s73, s73, 16
    s_add_u32 s82, s83, s73
    s_lshl_b32 s72, s65, 6
    s_add_u32 s72, s72, s64
    s_lshl1_add_u32 s72, s72, s74
    s_lshl_b32 s72, s72, 10
    s_add_u32 s72, s72, 1048576
    s_mul_i32 s84, s74, 27648
    s_add_u32 s84, s84, 65536
    s_xor_b32 s73, s75, 3
    s_mul_i32 s96, s73, 6912
    s_lshl_b32 s73, s73, 15
    s_add_u32 s92, s72, s73
    s_add_u32 s96, s96, s84
    s_xor_b32 s73, s75, 2
    s_mul_i32 s97, s73, 6912
    s_lshl_b32 s73, s73, 15
    s_add_u32 s93, s72, s73
    s_add_u32 s97, s97, s84
    s_xor_b32 s73, s75, 1
    s_mul_i32 s98, s73, 6912
    s_lshl_b32 s73, s73, 15
    s_add_u32 s94, s72, s73
    s_add_u32 s98, s98, s84
    s_xor_b32 s73, s75, 0
    s_mul_i32 s99, s73, 6912
    s_lshl_b32 s73, s73, 15
    s_add_u32 s95, s72, s73
    s_add_u32 s99, s99, s84
    v_mov_b32 v128, 0
    v_mov_b32 v129, 0
    v_mov_b32 v130, 0
    v_mov_b32 v131, 0
    v_mov_b32 v132, 0
    v_mov_b32 v133, 0
    v_mov_b32 v134, 0
    v_mov_b32 v135, 0
    v_mov_b32 v136, 0
    v_mov_b32 v137, 0
    v_mov_b32 v138, 0
    v_mov_b32 v139, 0
    v_mov_b32 v140, 0
    v_mov_b32 v141, 0
    v_mov_b32 v142, 0
    v_mov_b32 v143, 0
    v_mov_b32 v144, 0
    v_mov_b32 v145, 0
    v_mov_b32 v146, 0
    v_mov_b32 v147, 0
    v_mov_b32 v148, 0
    v_mov_b32 v149, 0
    v_mov_b32 v150, 0
    v_mov_b32 v151, 0
    v_mov_b32 v152, 0
    v_mov_b32 v153, 0
    v_mov_b32 v154, 0
    v_mov_b32 v155, 0
    v_mov_b32 v156, 0
    v_mov_b32 v157, 0
    v_mov_b32 v158, 0
    v_mov_b32 v159, 0
    v_mov_b32 v160, 0
    v_mov_b32 v161, 0
    v_mov_b32 v162, 0
    v_mov_b32 v163, 0
    v_mov_b32 v164, 0
    v_mov_b32 v165, 0
    v_mov_b32 v166, 0
    v_mov_b32 v167, 0
    v_mov_b32 v168, 0
    v_mov_b32 v169, 0
    v_mov_b32 v170, 0
    v_mov_b32 v171, 0
    v_mov_b32 v172, 0
    v_mov_b32 v173, 0
    v_mov_b32 v174, 0
    v_mov_b32 v175, 0
    v_mov_b32 v176, 0
    v_mov_b32 v177, 0
    v_mov_b32 v178, 0
    v_mov_b32 v179, 0
    v_mov_b32 v180, 0
    v_mov_b32 v181, 0
    v_mov_b32 v182, 0
    v_mov_b32 v183, 0
    v_mov_b32 v184, 0
    v_mov_b32 v185, 0
    v_mov_b32 v186, 0
    v_mov_b32 v187, 0
    v_mov_b32 v188, 0
    v_mov_b32 v189, 0
    v_mov_b32 v190, 0
    v_mov_b32 v191, 0
    v_and_b32 v7, 27, v0
    v_cmp_eq_u32 vcc, 16, v7
    v_mov_b32 v7, 0x3f803f80
    s_nop 0
    v_cndmask_b32 v7, 0, v7, vcc
    v_mov_b32 v196, v7
    v_mov_b32 v197, v7
    v_mov_b32 v198, v7
    v_mov_b32 v199, v7
    v_mov_b32 v200, v7
    v_mov_b32 v201, v7
    v_mov_b32 v202, v7
    v_mov_b32 v203, v7
    v_mov_b32 v208, v7
    v_mov_b32 v209, v7
    v_mov_b32 v210, v7
    v_mov_b32 v211, v7
    v_mov_b32 v212, v7
    v_mov_b32 v213, v7
    v_mov_b32 v214, v7
    v_mov_b32 v215, v7
    v_mov_b32 v220, v7
    v_mov_b32 v221, v7
    v_mov_b32 v222, v7
    v_mov_b32 v223, v7
    v_mov_b32 v224, v7
    v_mov_b32 v225, v7
    v_mov_b32 v226, v7
    v_mov_b32 v227, v7
    s_waitcnt lgkmcnt(0)
    s_add_u32 s68, s68, 0x9e3779b9
    s_waitcnt vmcnt(6)
    s_barrier
    s_xor_b32 s73, s67, 2
    s_mul_i32 s73, s73, 176128
    s_add_u32 s73, s73, s80
    s_add_u32 m0, s87, 49152
    s_add_u32 s72, s73, 0
    buffer_load_dwordx4 v56, s[36:39], s72 offen offset:0 lds
    s_add_u32 m0, s87, 51200
    s_add_u32 s72, s73, 128
    buffer_load_dwordx4 v56, s[36:39], s72 offen offset:0 lds
    s_add_u32 m0, s87, 53248
    s_add_u32 s72, s73, 256
    buffer_load_dwordx4 v57, s[36:39], s72 offen offset:0 lds
    s_add_u32 m0, s87, 50176
    s_add_u32 s72, s73, 22016
    buffer_load_dwordx4 v58, s[36:39], s72 offen offset:0 lds
    s_add_u32 m0, s87, 52224
    s_add_u32 s72, s73, 22144
    buffer_load_dwordx4 v58, s[36:39], s72 offen offset:0 lds
    s_add_u32 m0, s87, 54272
    s_add_u32 s72, s73, 22272
    buffer_load_dwordx4 v59, s[36:39], s72 offen offset:0 lds
    s_waitcnt vmcnt(6)
    s_barrier
    s_xor_b32 s73, s67, 3
    s_mul_i32 s73, s73, 176128
    s_add_u32 s73, s73, s80
    s_add_u32 m0, s87, 73728
    s_add_u32 s72, s73, 0
    buffer_load_dwordx4 v56, s[36:39], s72 offen offset:0 lds
    s_add_u32 m0, s87, 75776
    s_add_u32 s72, s73, 128
    buffer_load_dwordx4 v56, s[36:39], s72 offen offset:0 lds
    s_add_u32 m0, s87, 77824
    s_add_u32 s72, s73, 256
    buffer_load_dwordx4 v57, s[36:39], s72 offen offset:0 lds
    s_add_u32 m0, s87, 74752
    s_add_u32 s72, s73, 22016
    buffer_load_dwordx4 v58, s[36:39], s72 offen offset:0 lds
    s_add_u32 m0, s87, 76800
    s_add_u32 s72, s73, 22144
    buffer_load_dwordx4 v58, s[36:39], s72 offen offset:0 lds
    s_add_u32 m0, s87, 78848
    s_add_u32 s72, s73, 22272
    buffer_load_dwordx4 v59, s[36:39], s72 offen offset:0 lds
    s_waitcnt vmcnt(6)
    s_barrier
    s_xor_b32 s73, s67, 4
    s_mul_i32 s73, s73, 176128
    s_add_u32 s73, s73, s80
    s_add_u32 m0, s87, 0
    s_add_u32 s72, s73, 0
    buffer_load_dwordx4 v56, s[36:39], s72 offen offset:0 lds
    s_add_u32 m0, s87, 2048
    s_add_u32 s72, s73, 128
    buffer_load_dwordx4 v56, s[36:39], s72 offen offset:0 lds
    s_add_u32 m0, s87, 4096
    s_add_u32 s72, s73, 256
    buffer_load_dwordx4 v57, s[36:39], s72 offen offset:0 lds
    s_add_u32 m0, s87, 1024
    s_add_u32 s72, s73, 22016
    buffer_load_dwordx4 v58, s[36:39], s72 offen offset:0 lds
    s_add_u32 m0, s87, 3072
    s_add_u32 s72, s73, 22144
    buffer_load_dwordx4 v58, s[36:39], s72 offen offset:0 lds
    s_add_u32 m0, s87, 5120
    s_add_u32 s72, s73, 22272
    buffer_load_dwordx4 v59, s[36:39], s72 offen offset:0 lds
    s_waitcnt vmcnt(6)
    s_barrier
    s_xor_b32 s73, s67, 5
    s_mul_i32 s73, s73, 176128
    s_add_u32 s73, s73, s80
    s_add_u32 m0, s87, 24576
    s_add_u32 s72, s73, 0
    buffer_load_dwordx4 v56, s[36:39], s72 offen offset:0 lds
    s_add_u32 m0, s87, 26624
    s_add_u32 s72, s73, 128
    buffer_load_dwordx4 v56, s[36:39], s72 offen offset:0 lds
    s_add_u32 m0, s87, 28672
    s_add_u32 s72, s73, 256
    buffer_load_dwordx4 v57, s[36:39], s72 offen offset:0 lds
    s_add_u32 m0, s87, 25600
    s_add_u32 s72, s73, 22016
    buffer_load_dwordx4 v58, s[36:39], s72 offen offset:0 lds
    s_add_u32 m0, s87, 27648
    s_add_u32 s72, s73, 22144
    buffer_load_dwordx4 v58, s[36:39], s72 offen offset:0 lds
    s_add_u32 m0, s87, 29696
    s_add_u32 s72, s73, 22272
    buffer_load_dwordx4 v59, s[36:39], s72 offen offset:0 lds
    s_waitcnt vmcnt(6)
    s_barrier
    s_xor_b32 s73, s67, 6
    s_mul_i32 s73, s73, 176128
    s_add_u32 s73, s73, s80
    s_add_u32 m0, s87, 49152
    s_add_u32 s72, s73, 0
    buffer_load_dwordx4 v56, s[36:39], s72 offen offset:0 lds
    s_add_u32 m0, s87, 51200
    s_add_u32 s72, s73, 128
    buffer_load_dwordx4 v56, s[36:39], s72 offen offset:0 lds
    s_add_u32 m0, s87, 53248
    s_add_u32 s72, s73, 256
    buffer_load_dwordx4 v57, s[36:39], s72 offen offset:0 lds
    s_add_u32 m0, s87, 50176
    s_add_u32 s72, s73, 22016
    buffer_load_dwordx4 v58, s[36:39], s72 offen offset:0 lds
    s_add_u32 m0, s87, 52224
    s_add_u32 s72, s73, 22144
    buffer_load_dwordx4 v58, s[36:39], s72 offen offset:0 lds
    s_add_u32 m0, s87, 54272
    s_add_u32 s72, s73, 22272
    buffer_load_dwordx4 v59, s[36:39], s72 offen offset:0 lds
    s_waitcnt vmcnt(6)
    s_barrier
    s_xor_b32 s73, s67, 7
    s_mul_i32 s73, s73, 176128
    s_add_u32 s73, s73, s80
    s_add_u32 m0, s87, 73728
    s_add_u32 s72, s73, 0
    buffer_load_dwordx4 v56, s[36:39], s72 offen offset:0 lds
    s_add_u32 m0, s87, 75776
    s_add_u32 s72, s73, 128
    buffer_load_dwordx4 v56, s[36:39], s72 offen offset:0 lds
    s_add_u32 m0, s87, 77824
    s_add_u32 s72, s73, 256
    buffer_load_dwordx4 v57, s[36:39], s72 offen offset:0 lds
    s_add_u32 m0, s87, 74752
    s_add_u32 s72, s73, 22016
    buffer_load_dwordx4 v58, s[36:39], s72 offen offset:0 lds
    s_add_u32 m0, s87, 76800
    s_add_u32 s72, s73, 22144
    buffer_load_dwordx4 v58, s[36:39], s72 offen offset:0 lds
    s_add_u32 m0, s87, 78848
    s_add_u32 s72, s73, 22272
    buffer_load_dwordx4 v59, s[36:39], s72 offen offset:0 lds
    s_waitcnt vmcnt(6)
    s_barrier
    v_and_b32 v7, 31, v0
    v_lshlrev_b32 v7, 4, v7
    buffer_load_dword v7, v7, s[56:59], s79 offen offset:0 sc0 sc1
    s_waitcnt vmcnt(1)
    s_barrier
    s_waitcnt vmcnt(0)
    v_cmp_ne_u32 vcc, s68, v7
    s_cbranch_vccnz L_poll_q
L_polled_q:
    v_and_b32 v252, 0x230, v1
    v_and_b32 v253, 0x180, v1
    v_lshrrev_b32 v253, 1, v253
    v_and_b32 v254, 64, v1
    v_lshlrev_b32 v254, 2, v254
    v_or3_b32 v252, v252, v253, v254
    buffer_load_dwordx4 v[8:11], v1, s[56:59], s92 offen offset:0 sc1
    buffer_load_dwordx4 v[192:195], v252, s[56:59], s82 offen offset:0 sc1
    s_mov_b64 exec, s[70:71]
    buffer_load_dwordx4 v[196:199], v2, s[56:59], s82 offen offset:1024 sc1
    buffer_load_dwordx4 v[200:203], v2, s[56:59], s82 offen offset:1536 sc1
    s_mov_b64 exec, -1
    s_add_u32 s82, s82, 2048
    buffer_load_dwordx4 v[12:15], v1, s[56:59], s93 offen offset:0 sc1
    buffer_load_dwordx4 v[16:19], v1, s[56:59], s94 offen offset:0 sc1
    buffer_load_dwordx4 v[20:23], v1, s[56:59], s95 offen offset:0 sc1
    buffer_load_dwordx4 v[204:207], v252, s[56:59], s82 offen offset:0 sc1
    s_mov_b64 exec, s[70:71]
    buffer_load_dwordx4 v[208:211], v2, s[56:59], s82 offen offset:1024 sc1
    buffer_load_dwordx4 v[212:215], v2, s[56:59], s82 offen offset:1536 sc1
    s_mov_b64 exec, -1
    s_add_u32 s82, s82, 2048
    s_barrier
    s_setprio 1
    buffer_load_dwordx4 v[216:219], v252, s[56:59], s82 offen offset:0 sc1
    s_mov_b64 exec, s[70:71]
    buffer_load_dwordx4 v[220:223], v2, s[56:59], s82 offen offset:1024 sc1
    buffer_load_dwordx4 v[224:227], v2, s[56:59], s82 offen offset:1536 sc1
    s_mov_b64 exec, -1
    s_add_u32 s82, s82, 2048
    s_waitcnt vmcnt(6)
    v_mfma_f32_32x32x16_bf16 v[24:39], v[192:195], v[8:11], 0
    s_nop 11
    v_exp_f32 v24, v24
    v_exp_f32 v25, v25
    v_exp_f32 v26, v26
    v_exp_f32 v27, v27
    v_exp_f32 v28, v28
    v_mfma_f32_32x32x16_bf16 v[40:55], v[192:195], v[12:15], 0
    v_exp_f32 v29, v29
    v_exp_f32 v30, v30
    v_exp_f32 v31, v31
    v_exp_f32 v32, v32
    v_exp_f32 v33, v33
    v_exp_f32 v34, v34
    v_smfmac_f32_32x32x32_bf16 v[128:143], v[196:199], v[24:31], v3
    v_exp_f32 v35, v35
    v_exp_f32 v36, v36
    v_exp_f32 v37, v37
    v_exp_f32 v38, v38
    v_exp_f32 v39, v39
    v_exp_f32 v40, v40
    v_exp_f32 v41, v41
    v_smfmac_f32_32x32x32_bf16 v[128:143], v[200:203], v[32:39], v3
    v_exp_f32 v42, v42
    v_exp_f32 v43, v43
    v_exp_f32 v44, v44
    v_mfma_f32_32x32x16_bf16 v[24:39], v[192:195], v[16:19], 0
    v_exp_f32 v45, v45
    v_exp_f32 v46, v46
    v_exp_f32 v47, v47
    v_exp_f32 v48, v48
    v_exp_f32 v49, v49
    v_exp_f32 v50, v50
    v_smfmac_f32_32x32x32_bf16 v[144:159], v[196:199], v[40:47], v3
    v_exp_f32 v51, v51
    v_exp_f32 v52, v52
    v_exp_f32 v53, v53
    v_exp_f32 v54, v54
    v_exp_f32 v55, v55
    v_exp_f32 v24, v24
    v_exp_f32 v25, v25
    v_smfmac_f32_32x32x32_bf16 v[144:159], v[200:203], v[48:55], v3
    v_exp_f32 v26, v26
    v_exp_f32 v27, v27
    v_exp_f32 v28, v28
    v_mfma_f32_32x32x16_bf16 v[40:55], v[192:195], v[20:23], 0
    v_exp_f32 v29, v29
    v_exp_f32 v30, v30
    v_exp_f32 v31, v31
    v_exp_f32 v32, v32
    v_exp_f32 v33, v33
    v_exp_f32 v34, v34
    v_smfmac_f32_32x32x32_bf16 v[160:175], v[196:199], v[24:31], v3
    v_exp_f32 v35, v35
    v_exp_f32 v36, v36
    v_exp_f32 v37, v37
    v_exp_f32 v38, v38
    v_exp_f32 v39, v39
    v_exp_f32 v40, v40
    v_exp_f32 v41, v41
    v_smfmac_f32_32x32x32_bf16 v[160:175], v[200:203], v[32:39], v3
    v_exp_f32 v42, v42
    v_exp_f32 v43, v43
    v_exp_f32 v44, v44
    s_waitcnt vmcnt(3)
    v_mfma_f32_32x32x16_bf16 v[24:39], v[204:207], v[8:11], 0
    v_exp_f32 v45, v45
    v_exp_f32 v46, v46
    v_exp_f32 v47, v47
    v_exp_f32 v48, v48
    v_exp_f32 v49, v49
    v_exp_f32 v50, v50
    v_smfmac_f32_32x32x32_bf16 v[176:191], v[196:199], v[40:47], v3
    v_exp_f32 v51, v51
    v_exp_f32 v52, v52
    v_exp_f32 v53, v53
    v_exp_f32 v54, v54
    v_exp_f32 v55, v55
    v_exp_f32 v24, v24
    v_exp_f32 v25, v25
    v_smfmac_f32_32x32x32_bf16 v[176:191], v[200:203], v[48:55], v3
    v_exp_f32 v26, v26
    v_exp_f32 v27, v27
    v_exp_f32 v28, v28
    buffer_load_dwordx4 v[192:195], v252, s[56:59], s82 offen offset:0 sc1
    s_mov_b64 exec, s[70:71]
    buffer_load_dwordx4 v[196:199], v2, s[56:59], s82 offen offset:1024 sc1
    buffer_load_dwordx4 v[200:203], v2, s[56:59], s82 offen offset:1536 sc1
    s_mov_b64 exec, -1
    s_add_u32 s82, s82, 2048
    v_mfma_f32_32x32x16_bf16 v[40:55], v[204:207], v[12:15], 0
    v_exp_f32 v29, v29
    v_exp_f32 v30, v30
    v_exp_f32 v31, v31
    v_exp_f32 v32, v32
    v_exp_f32 v33, v33
    v_exp_f32 v34, v34
    v_smfmac_f32_32x32x32_bf16 v[128:143], v[208:211], v[24:31], v3
    v_exp_f32 v35, v35
    v_exp_f32 v36, v36
    v_exp_f32 v37, v37
    v_exp_f32 v38, v38
    v_exp_f32 v39, v39
    v_exp_f32 v40, v40
    v_exp_f32 v41, v41
    v_smfmac_f32_32x32x32_bf16 v[128:143], v[212:215], v[32:39], v3
    v_exp_f32 v42, v42
    v_exp_f32 v43, v43
    v_exp_f32 v44, v44
    v_mfma_f32_32x32x16_bf16 v[24:39], v[204:207], v[16:19], 0
    v_exp_f32 v45, v45
    v_exp_f32 v46, v46
    v_exp_f32 v47, v47
    v_exp_f32 v48, v48
    v_exp_f32 v49, v49
    v_exp_f32 v50, v50
    v_smfmac_f32_32x32x32_bf16 v[144:159], v[208:211], v[40:47], v3
    v_exp_f32 v51, v51
    v_exp_f32 v52, v52
    v_exp_f32 v53, v53
    v_exp_f32 v54, v54
    v_exp_f32 v55, v55
    v_exp_f32 v24, v24
    v_exp_f32 v25, v25
    v_smfmac_f32_32x32x32_bf16 v[144:159], v[212:215], v[48:55], v3
    v_exp_f32 v26, v26
    v_exp_f32 v27, v27
    v_exp_f32 v28, v28
    v_mfma_f32_32x32x16_bf16 v[40:55], v[204:207], v[20:23], 0
    v_exp_f32 v29, v29
    v_exp_f32 v30, v30
    v_exp_f32 v31, v31
    v_exp_f32 v32, v32
    v_exp_f32 v33, v33
    v_exp_f32 v34, v34
    v_smfmac_f32_32x32x32_bf16 v[160:175], v[208:211], v[24:31], v3
    v_exp_f32 v35, v35
    v_exp_f32 v36, v36
    v_exp_f32 v37, v37
    v_exp_f32 v38, v38
    v_exp_f32 v39, v39
    v_exp_f32 v40, v40
    v_exp_f32 v41, v41
    v_smfmac_f32_32x32x32_bf16 v[160:175], v[212:215], v[32:39], v3
    v_exp_f32 v42, v42
    v_exp_f32 v43, v43
    v_exp_f32 v44, v44
    s_waitcnt vmcnt(3)
    v_mfma_f32_32x32x16_bf16 v[24:39], v[216:219], v[8:11], 0
    v_exp_f32 v45, v45
    v_exp_f32 v46, v46
    v_exp_f32 v47, v47
    v_exp_f32 v48, v48
    v_exp_f32 v49, v49
    v_exp_f32 v50, v50
    v_smfmac_f32_32x32x32_bf16 v[176:191], v[208:211], v[40:47], v3
    v_exp_f32 v51, v51
    v_exp_f32 v52, v52
    v_exp_f32 v53, v53
    v_exp_f32 v54, v54
    v_exp_f32 v55, v55
    v_exp_f32 v24, v24
    v_exp_f32 v25, v25
    v_smfmac_f32_32x32x32_bf16 v[176:191], v[212:215], v[48:55], v3
    v_exp_f32 v26, v26
    v_exp_f32 v27, v27
    v_exp_f32 v28, v28
    buffer_load_dwordx4 v[204:207], v252, s[56:59], s82 offen offset:0 sc1
    s_mov_b64 exec, s[70:71]
    buffer_load_dwordx4 v[208:211], v2, s[56:59], s82 offen offset:1024 sc1
    buffer_load_dwordx4 v[212:215], v2, s[56:59], s82 offen offset:1536 sc1
    s_mov_b64 exec, -1
    s_add_u32 s82, s82, 2048
    v_mfma_f32_32x32x16_bf16 v[40:55], v[216:219], v[12:15], 0
    v_exp_f32 v29, v29
    v_exp_f32 v30, v30
    v_exp_f32 v31, v31
    v_exp_f32 v32, v32
    v_exp_f32 v33, v33
    v_exp_f32 v34, v34
    v_smfmac_f32_32x32x32_bf16 v[128:143], v[220:223], v[24:31], v3
    v_exp_f32 v35, v35
    v_exp_f32 v36, v36
    v_exp_f32 v37, v37
    v_exp_f32 v38, v38
    v_exp_f32 v39, v39
    v_exp_f32 v40, v40
    v_exp_f32 v41, v41
    v_smfmac_f32_32x32x32_bf16 v[128:143], v[224:227], v[32:39], v3
    v_exp_f32 v42, v42
    v_exp_f32 v43, v43
    v_exp_f32 v44, v44
    v_mfma_f32_32x32x16_bf16 v[24:39], v[216:219], v[16:19], 0
    v_exp_f32 v45, v45
    v_exp_f32 v46, v46
    v_exp_f32 v47, v47
    v_exp_f32 v48, v48
    v_exp_f32 v49, v49
    v_exp_f32 v50, v50
    v_smfmac_f32_32x32x32_bf16 v[144:159], v[220:223], v[40:47], v3
    v_exp_f32 v51, v51
    v_exp_f32 v52, v52
    v_exp_f32 v53, v53
    v_exp_f32 v54, v54
    v_exp_f32 v55, v55
    v_exp_f32 v24, v24
    v_exp_f32 v25, v25
    v_smfmac_f32_32x32x32_bf16 v[144:159], v[224:227], v[48:55], v3
    v_exp_f32 v26, v26
    v_exp_f32 v27, v27
    v_exp_f32 v28, v28
    v_mfma_f32_32x32x16_bf16 v[40:55], v[216:219], v[20:23], 0
    v_exp_f32 v29, v29
    v_exp_f32 v30, v30
    v_exp_f32 v31, v31
    v_exp_f32 v32, v32
    v_exp_f32 v33, v33
    v_exp_f32 v34, v34
    v_smfmac_f32_32x32x32_bf16 v[160:175], v[220:223], v[24:31], v3
    v_exp_f32 v35, v35
    v_exp_f32 v36, v36
    v_exp_f32 v37, v37
    v_exp_f32 v38, v38
    v_exp_f32 v39, v39
    v_exp_f32 v40, v40
    v_exp_f32 v41, v41
    v_smfmac_f32_32x32x32_bf16 v[160:175], v[224:227], v[32:39], v3
    v_exp_f32 v42, v42
    v_exp_f32 v43, v43
    v_exp_f32 v44, v44
    s_waitcnt vmcnt(3)
    v_mfma_f32_32x32x16_bf16 v[24:39], v[192:195], v[8:11], 0
    v_exp_f32 v45, v45
    v_exp_f32 v46, v46
    v_exp_f32 v47, v47
    v_exp_f32 v48, v48
    v_exp_f32 v49, v49
    v_exp_f32 v50, v50
    v_smfmac_f32_32x32x32_bf16 v[176:191], v[220:223], v[40:47], v3
    v_exp_f32 v51, v51
    v_exp_f32 v52, v52
    v_exp_f32 v53, v53
    v_exp_f32 v54, v54
    v_exp_f32 v55, v55
    v_exp_f32 v24, v24
    v_exp_f32 v25, v25
    v_smfmac_f32_32x32x32_bf16 v[176:191], v[224:227], v[48:55], v3
    v_exp_f32 v26, v26
    v_exp_f32 v27, v27
    v_exp_f32 v28, v28
    buffer_load_dwordx4 v[216:219], v252, s[56:59], s82 offen offset:0 sc1
    s_mov_b64 exec, s[70:71]
    buffer_load_dwordx4 v[220:223], v2, s[56:59], s82 offen offset:1024 sc1
    buffer_load_dwordx4 v[224:227], v2, s[56:59], s82 offen offset:1536 sc1
    s_mov_b64 exec, -1
    s_add_u32 s82, s82, 2048
    v_mfma_f32_32x32x16_bf16 v[40:55], v[192:195], v[12:15], 0
    v_exp_f32 v29, v29
    v_exp_f32 v30, v30
    v_exp_f32 v31, v31
    v_exp_f32 v32, v32
    v_exp_f32 v33, v33
    v_exp_f32 v34, v34
    v_smfmac_f32_32x32x32_bf16 v[128:143], v[196:199], v[24:31], v3
    v_exp_f32 v35, v35
    v_exp_f32 v36, v36
    v_exp_f32 v37, v37
    v_exp_f32 v38, v38
    v_exp_f32 v39, v39
    v_exp_f32 v40, v40
    v_exp_f32 v41, v41
    v_smfmac_f32_32x32x32_bf16 v[128:143], v[200:203], v[32:39], v3
    v_exp_f32 v42, v42
    v_exp_f32 v43, v43
    v_exp_f32 v44, v44
    v_mfma_f32_32x32x16_bf16 v[24:39], v[192:195], v[16:19], 0
    v_exp_f32 v45, v45
    v_exp_f32 v46, v46
    v_exp_f32 v47, v47
    v_exp_f32 v48, v48
    v_exp_f32 v49, v49
    v_exp_f32 v50, v50
    v_smfmac_f32_32x32x32_bf16 v[144:159], v[196:199], v[40:47], v3
    v_exp_f32 v51, v51
    v_exp_f32 v52, v52
    v_exp_f32 v53, v53
    v_exp_f32 v54, v54
    v_exp_f32 v55, v55
    v_exp_f32 v24, v24
    v_exp_f32 v25, v25
    v_smfmac_f32_32x32x32_bf16 v[144:159], v[200:203], v[48:55], v3
    v_exp_f32 v26, v26
    v_exp_f32 v27, v27
    v_exp_f32 v28, v28
    v_mfma_f32_32x32x16_bf16 v[40:55], v[192:195], v[20:23], 0
    v_exp_f32 v29, v29
    v_exp_f32 v30, v30
    v_exp_f32 v31, v31
    v_exp_f32 v32, v32
    v_exp_f32 v33, v33
    v_exp_f32 v34, v34
    v_smfmac_f32_32x32x32_bf16 v[160:175], v[196:199], v[24:31], v3
    v_exp_f32 v35, v35
    v_exp_f32 v36, v36
    v_exp_f32 v37, v37
    v_exp_f32 v38, v38
    v_exp_f32 v39, v39
    v_exp_f32 v40, v40
    v_exp_f32 v41, v41
    v_smfmac_f32_32x32x32_bf16 v[160:175], v[200:203], v[32:39], v3
    v_exp_f32 v42, v42
    v_exp_f32 v43, v43
    v_exp_f32 v44, v44
    s_waitcnt vmcnt(3)
    v_mfma_f32_32x32x16_bf16 v[24:39], v[204:207], v[8:11], 0
    v_exp_f32 v45, v45
    v_exp_f32 v46, v46
    v_exp_f32 v47, v47
    v_exp_f32 v48, v48
    v_exp_f32 v49, v49
    v_exp_f32 v50, v50
    v_smfmac_f32_32x32x32_bf16 v[176:191], v[196:199], v[40:47], v3
    v_exp_f32 v51, v51
    v_exp_f32 v52, v52
    v_exp_f32 v53, v53
    v_exp_f32 v54, v54
    v_exp_f32 v55, v55
    v_exp_f32 v24, v24
    v_exp_f32 v25, v25
    v_smfmac_f32_32x32x32_bf16 v[176:191], v[200:203], v[48:55], v3
    v_exp_f32 v26, v26
    v_exp_f32 v27, v27
    v_exp_f32 v28, v28
    buffer_load_dwordx4 v[192:195], v252, s[56:59], s82 offen offset:0 sc1
    s_mov_b64 exec, s[70:71]
    buffer_load_dwordx4 v[196:199], v2, s[56:59], s82 offen offset:1024 sc1
    buffer_load_dwordx4 v[200:203], v2, s[56:59], s82 offen offset:1536 sc1
    s_mov_b64 exec, -1
    s_add_u32 s82, s82, 2048
    v_mfma_f32_32x32x16_bf16 v[40:55], v[204:207], v[12:15], 0
    v_exp_f32 v29, v29
    v_exp_f32 v30, v30
    v_exp_f32 v31, v31
    v_exp_f32 v32, v32
    v_exp_f32 v33, v33
    v_exp_f32 v34, v34
    v_smfmac_f32_32x32x32_bf16 v[128:143], v[208:211], v[24:31], v3
    v_exp_f32 v35, v35
    v_exp_f32 v36, v36
    v_exp_f32 v37, v37
    v_exp_f32 v38, v38
    v_exp_f32 v39, v39
    v_exp_f32 v40, v40
    v_exp_f32 v41, v41
    v_smfmac_f32_32x32x32_bf16 v[128:143], v[212:215], v[32:39], v3
    v_exp_f32 v42, v42
    v_exp_f32 v43, v43
    v_exp_f32 v44, v44
    v_mfma_f32_32x32x16_bf16 v[24:39], v[204:207], v[16:19], 0
    v_exp_f32 v45, v45
    v_exp_f32 v46, v46
    v_exp_f32 v47, v47
    v_exp_f32 v48, v48
    v_exp_f32 v49, v49
    v_exp_f32 v50, v50
    v_smfmac_f32_32x32x32_bf16 v[144:159], v[208:211], v[40:47], v3
    v_exp_f32 v51, v51
    v_exp_f32 v52, v52
    v_exp_f32 v53, v53
    v_exp_f32 v54, v54
    v_exp_f32 v55, v55
    v_exp_f32 v24, v24
    v_exp_f32 v25, v25
    v_smfmac_f32_32x32x32_bf16 v[144:159], v[212:215], v[48:55], v3
    v_exp_f32 v26, v26
    v_exp_f32 v27, v27
    v_exp_f32 v28, v28
    v_mfma_f32_32x32x16_bf16 v[40:55], v[204:207], v[20:23], 0
    v_exp_f32 v29, v29
    v_exp_f32 v30, v30
    v_exp_f32 v31, v31
    v_exp_f32 v32, v32
    v_exp_f32 v33, v33
    v_exp_f32 v34, v34
    v_smfmac_f32_32x32x32_bf16 v[160:175], v[208:211], v[24:31], v3
    v_exp_f32 v35, v35
    v_exp_f32 v36, v36
    v_exp_f32 v37, v37
    v_exp_f32 v38, v38
    v_exp_f32 v39, v39
    v_exp_f32 v40, v40
    v_exp_f32 v41, v41
    v_smfmac_f32_32x32x32_bf16 v[160:175], v[212:215], v[32:39], v3
    v_exp_f32 v42, v42
    v_exp_f32 v43, v43
    v_exp_f32 v44, v44
    s_waitcnt vmcnt(3)
    v_mfma_f32_32x32x16_bf16 v[24:39], v[216:219], v[8:11], 0
    v_exp_f32 v45, v45
    v_exp_f32 v46, v46
    v_exp_f32 v47, v47
    v_exp_f32 v48, v48
    v_exp_f32 v49, v49
    v_exp_f32 v50, v50
    v_smfmac_f32_32x32x32_bf16 v[176:191], v[208:211], v[40:47], v3
    v_exp_f32 v51, v51
    v_exp_f32 v52, v52
    v_exp_f32 v53, v53
    v_exp_f32 v54, v54
    v_exp_f32 v55, v55
    v_exp_f32 v24, v24
    v_exp_f32 v25, v25
    v_smfmac_f32_32x32x32_bf16 v[176:191], v[212:215], v[48:55], v3
    v_exp_f32 v26, v26
    v_exp_f32 v27, v27
    v_exp_f32 v28, v28
    buffer_load_dwordx4 v[204:207], v252, s[56:59], s82 offen offset:0 sc1
    s_mov_b64 exec, s[70:71]
    buffer_load_dwordx4 v[208:211], v2, s[56:59], s82 offen offset:1024 sc1
    buffer_load_dwordx4 v[212:215], v2, s[56:59], s82 offen offset:1536 sc1
    s_mov_b64 exec, -1
    s_add_u32 s82, s82, 2048
    v_mfma_f32_32x32x16_bf16 v[40:55], v[216:219], v[12:15], 0
    v_exp_f32 v29, v29
    v_exp_f32 v30, v30
    v_exp_f32 v31, v31
    v_exp_f32 v32, v32
    v_exp_f32 v33, v33
    v_exp_f32 v34, v34
    v_smfmac_f32_32x32x32_bf16 v[128:143], v[220:223], v[24:31], v3
    v_exp_f32 v35, v35
    v_exp_f32 v36, v36
    v_exp_f32 v37, v37
    v_exp_f32 v38, v38
    v_exp_f32 v39, v39
    v_exp_f32 v40, v40
    v_exp_f32 v41, v41
    v_smfmac_f32_32x32x32_bf16 v[128:143], v[224:227], v[32:39], v3
    v_exp_f32 v42, v42
    v_exp_f32 v43, v43
    v_exp_f32 v44, v44
    v_mfma_f32_32x32x16_bf16 v[24:39], v[216:219], v[16:19], 0
    v_exp_f32 v45, v45
    v_exp_f32 v46, v46
    v_exp_f32 v47, v47
    v_exp_f32 v48, v48
    v_exp_f32 v49, v49
    v_exp_f32 v50, v50
    v_smfmac_f32_32x32x32_bf16 v[144:159], v[220:223], v[40:47], v3
    v_exp_f32 v51, v51
    v_exp_f32 v52, v52
    v_exp_f32 v53, v53
    v_exp_f32 v54, v54
    v_exp_f32 v55, v55
    v_exp_f32 v24, v24
    v_exp_f32 v25, v25
    v_smfmac_f32_32x32x32_bf16 v[144:159], v[224:227], v[48:55], v3
    v_exp_f32 v26, v26
    v_exp_f32 v27, v27
    v_exp_f32 v28, v28
    v_mfma_f32_32x32x16_bf16 v[40:55], v[216:219], v[20:23], 0
    v_exp_f32 v29, v29
    v_exp_f32 v30, v30
    v_exp_f32 v31, v31
    v_exp_f32 v32, v32
    v_exp_f32 v33, v33
    v_exp_f32 v34, v34
    v_smfmac_f32_32x32x32_bf16 v[160:175], v[220:223], v[24:31], v3
    v_exp_f32 v35, v35
    v_exp_f32 v36, v36
    v_exp_f32 v37, v37
    v_exp_f32 v38, v38
    v_exp_f32 v39, v39
    v_exp_f32 v40, v40
    v_exp_f32 v41, v41
    v_smfmac_f32_32x32x32_bf16 v[160:175], v[224:227], v[32:39], v3
    v_exp_f32 v42, v42
    v_exp_f32 v43, v43
    v_exp_f32 v44, v44
    s_waitcnt vmcnt(3)
    v_mfma_f32_32x32x16_bf16 v[24:39], v[192:195], v[8:11], 0
    v_exp_f32 v45, v45
    v_exp_f32 v46, v46
    v_exp_f32 v47, v47
    v_exp_f32 v48, v48
    v_exp_f32 v49, v49
    v_exp_f32 v50, v50
    v_smfmac_f32_32x32x32_bf16 v[176:191], v[220:223], v[40:47], v3
    v_exp_f32 v51, v51
    v_exp_f32 v52, v52
    v_exp_f32 v53, v53
    v_exp_f32 v54, v54
    v_exp_f32 v55, v55
    v_exp_f32 v24, v24
    v_exp_f32 v25, v25
    v_smfmac_f32_32x32x32_bf16 v[176:191], v[224:227], v[48:55], v3
    v_exp_f32 v26, v26
    v_exp_f32 v27, v27
    v_exp_f32 v28, v28
    buffer_load_dwordx4 v[216:219], v252, s[56:59], s82 offen offset:0 sc1
    s_mov_b64 exec, s[70:71]
    buffer_load_dwordx4 v[220:223], v2, s[56:59], s82 offen offset:1024 sc1
    buffer_load_dwordx4 v[224:227], v2, s[56:59], s82 offen offset:1536 sc1
    s_mov_b64 exec, -1
    s_add_u32 s82, s82, 2048
    v_mfma_f32_32x32x16_bf16 v[40:55], v[192:195], v[12:15], 0
    v_exp_f32 v29, v29
    v_exp_f32 v30, v30
    v_exp_f32 v31, v31
    v_exp_f32 v32, v32
    v_exp_f32 v33, v33
    v_exp_f32 v34, v34
    v_smfmac_f32_32x32x32_bf16 v[128:143], v[196:199], v[24:31], v3
    v_exp_f32 v35, v35
    v_exp_f32 v36, v36
    v_exp_f32 v37, v37
    v_exp_f32 v38, v38
    v_exp_f32 v39, v39
    v_exp_f32 v40, v40
    v_exp_f32 v41, v41
    v_smfmac_f32_32x32x32_bf16 v[128:143], v[200:203], v[32:39], v3
    v_exp_f32 v42, v42
    v_exp_f32 v43, v43
    v_exp_f32 v44, v44
    v_mfma_f32_32x32x16_bf16 v[24:39], v[192:195], v[16:19], 0
    v_exp_f32 v45, v45
    v_exp_f32 v46, v46
    v_exp_f32 v47, v47
    v_exp_f32 v48, v48
    v_exp_f32 v49, v49
    v_exp_f32 v50, v50
    v_smfmac_f32_32x32x32_bf16 v[144:159], v[196:199], v[40:47], v3
    v_exp_f32 v51, v51
    v_exp_f32 v52, v52
    v_exp_f32 v53, v53
    v_exp_f32 v54, v54
    v_exp_f32 v55, v55
    v_exp_f32 v24, v24
    v_exp_f32 v25, v25
    v_smfmac_f32_32x32x32_bf16 v[144:159], v[200:203], v[48:55], v3
    v_exp_f32 v26, v26
    v_exp_f32 v27, v27
    v_exp_f32 v28, v28
    v_mfma_f32_32x32x16_bf16 v[40:55], v[192:195], v[20:23], 0
    v_exp_f32 v29, v29
    v_exp_f32 v30, v30
    v_exp_f32 v31, v31
    v_exp_f32 v32, v32
    v_exp_f32 v33, v33
    v_exp_f32 v34, v34
    v_smfmac_f32_32x32x32_bf16 v[160:175], v[196:199], v[24:31], v3
    v_exp_f32 v35, v35
    v_exp_f32 v36, v36
    v_exp_f32 v37, v37
    v_exp_f32 v38, v38
    v_exp_f32 v39, v39
    v_exp_f32 v40, v40
    v_exp_f32 v41, v41
    v_smfmac_f32_32x32x32_bf16 v[160:175], v[200:203], v[32:39], v3
    v_exp_f32 v42, v42
    v_exp_f32 v43, v43
    v_exp_f32 v44, v44
    s_waitcnt vmcnt(3)
    v_mfma_f32_32x32x16_bf16 v[24:39], v[204:207], v[8:11], 0
    v_exp_f32 v45, v45
    v_exp_f32 v46, v46
    v_exp_f32 v47, v47
    v_exp_f32 v48, v48
    v_exp_f32 v49, v49
    v_exp_f32 v50, v50
    v_smfmac_f32_32x32x32_bf16 v[176:191], v[196:199], v[40:47], v3
    v_exp_f32 v51, v51
    v_exp_f32 v52, v52
    v_exp_f32 v53, v53
    v_exp_f32 v54, v54
    v_exp_f32 v55, v55
    v_exp_f32 v24, v24
    v_exp_f32 v25, v25
    v_smfmac_f32_32x32x32_bf16 v[176:191], v[200:203], v[48:55], v3
    v_exp_f32 v26, v26
    v_exp_f32 v27, v27
    v_exp_f32 v28, v28
    buffer_load_dwordx4 v[192:195], v252, s[56:59], s82 offen offset:0 sc1
    s_mov_b64 exec, s[70:71]
    buffer_load_dwordx4 v[196:199], v2, s[56:59], s82 offen offset:1024 sc1
    buffer_load_dwordx4 v[200:203], v2, s[56:59], s82 offen offset:1536 sc1
    s_mov_b64 exec, -1
    s_add_u32 s82, s82, 2048
    v_mfma_f32_32x32x16_bf16 v[40:55], v[204:207], v[12:15], 0
    v_exp_f32 v29, v29
    v_exp_f32 v30, v30
    v_exp_f32 v31, v31
    v_exp_f32 v32, v32
    v_exp_f32 v33, v33
    v_exp_f32 v34, v34
    v_smfmac_f32_32x32x32_bf16 v[128:143], v[208:211], v[24:31], v3
    v_exp_f32 v35, v35
    v_exp_f32 v36, v36
    v_exp_f32 v37, v37
    v_exp_f32 v38, v38
    v_exp_f32 v39, v39
    v_exp_f32 v40, v40
    v_exp_f32 v41, v41
    v_smfmac_f32_32x32x32_bf16 v[128:143], v[212:215], v[32:39], v3
    v_exp_f32 v42, v42
    v_exp_f32 v43, v43
    v_exp_f32 v44, v44
    v_mfma_f32_32x32x16_bf16 v[24:39], v[204:207], v[16:19], 0
    v_exp_f32 v45, v45
    v_exp_f32 v46, v46
    v_exp_f32 v47, v47
    v_exp_f32 v48, v48
    v_exp_f32 v49, v49
    v_exp_f32 v50, v50
    v_smfmac_f32_32x32x32_bf16 v[144:159], v[208:211], v[40:47], v3
    v_exp_f32 v51, v51
    v_exp_f32 v52, v52
    v_exp_f32 v53, v53
    v_exp_f32 v54, v54
    v_exp_f32 v55, v55
    v_exp_f32 v24, v24
    v_exp_f32 v25, v25
    v_smfmac_f32_32x32x32_bf16 v[144:159], v[212:215], v[48:55], v3
    v_exp_f32 v26, v26
    v_exp_f32 v27, v27
    v_exp_f32 v28, v28
    v_mfma_f32_32x32x16_bf16 v[40:55], v[204:207], v[20:23], 0
    v_exp_f32 v29, v29
    v_exp_f32 v30, v30
    v_exp_f32 v31, v31
    v_exp_f32 v32, v32
    v_exp_f32 v33, v33
    v_exp_f32 v34, v34
    v_smfmac_f32_32x32x32_bf16 v[160:175], v[208:211], v[24:31], v3
    v_exp_f32 v35, v35
    v_exp_f32 v36, v36
    v_exp_f32 v37, v37
    v_exp_f32 v38, v38
    v_exp_f32 v39, v39
    v_exp_f32 v40, v40
    v_exp_f32 v41, v41
    v_smfmac_f32_32x32x32_bf16 v[160:175], v[212:215], v[32:39], v3
    v_exp_f32 v42, v42
    v_exp_f32 v43, v43
    v_exp_f32 v44, v44
    s_waitcnt vmcnt(3)
    v_mfma_f32_32x32x16_bf16 v[24:39], v[216:219], v[8:11], 0
    v_exp_f32 v45, v45
    v_exp_f32 v46, v46
    v_exp_f32 v47, v47
    v_exp_f32 v48, v48
    v_exp_f32 v49, v49
    v_exp_f32 v50, v50
    v_smfmac_f32_32x32x32_bf16 v[176:191], v[208:211], v[40:47], v3
    v_exp_f32 v51, v51
    v_exp_f32 v52, v52
    v_exp_f32 v53, v53
    v_exp_f32 v54, v54
    v_exp_f32 v55, v55
    v_exp_f32 v24, v24
    v_exp_f32 v25, v25
    v_smfmac_f32_32x32x32_bf16 v[176:191], v[212:215], v[48:55], v3
    v_exp_f32 v26, v26
    v_exp_f32 v27, v27
    v_exp_f32 v28, v28
    buffer_load_dwordx4 v[204:207], v252, s[56:59], s82 offen offset:0 sc1
    s_mov_b64 exec, s[70:71]
    buffer_load_dwordx4 v[208:211], v2, s[56:59], s82 offen offset:1024 sc1
    buffer_load_dwordx4 v[212:215], v2, s[56:59], s82 offen offset:1536 sc1
    s_mov_b64 exec, -1
    s_add_u32 s82, s82, 43008
    v_mfma_f32_32x32x16_bf16 v[40:55], v[216:219], v[12:15], 0
    v_exp_f32 v29, v29
    v_exp_f32 v30, v30
    v_exp_f32 v31, v31
    v_exp_f32 v32, v32
    v_exp_f32 v33, v33
    v_exp_f32 v34, v34
    v_smfmac_f32_32x32x32_bf16 v[128:143], v[220:223], v[24:31], v3
    v_exp_f32 v35, v35
    v_exp_f32 v36, v36
    v_exp_f32 v37, v37
    v_exp_f32 v38, v38
    v_exp_f32 v39, v39
    v_exp_f32 v40, v40
    v_exp_f32 v41, v41
    v_smfmac_f32_32x32x32_bf16 v[128:143], v[224:227], v[32:39], v3
    v_exp_f32 v42, v42
    v_exp_f32 v43, v43
    v_exp_f32 v44, v44
    v_mfma_f32_32x32x16_bf16 v[24:39], v[216:219], v[16:19], 0
    v_exp_f32 v45, v45
    v_exp_f32 v46, v46
    v_exp_f32 v47, v47
    v_exp_f32 v48, v48
    v_exp_f32 v49, v49
    v_exp_f32 v50, v50
    v_smfmac_f32_32x32x32_bf16 v[144:159], v[220:223], v[40:47], v3
    v_exp_f32 v51, v51
    v_exp_f32 v52, v52
    v_exp_f32 v53, v53
    v_exp_f32 v54, v54
    v_exp_f32 v55, v55
    v_exp_f32 v24, v24
    v_exp_f32 v25, v25
    v_smfmac_f32_32x32x32_bf16 v[144:159], v[224:227], v[48:55], v3
    v_exp_f32 v26, v26
    v_exp_f32 v27, v27
    v_exp_f32 v28, v28
    v_mfma_f32_32x32x16_bf16 v[40:55], v[216:219], v[20:23], 0
    v_exp_f32 v29, v29
    v_exp_f32 v30, v30
    v_exp_f32 v31, v31
    v_exp_f32 v32, v32
    v_exp_f32 v33, v33
    v_exp_f32 v34, v34
    v_smfmac_f32_32x32x32_bf16 v[160:175], v[220:223], v[24:31], v3
    v_exp_f32 v35, v35
    v_exp_f32 v36, v36
    v_exp_f32 v37, v37
    v_exp_f32 v38, v38
    v_exp_f32 v39, v39
    v_exp_f32 v40, v40
    v_exp_f32 v41, v41
    v_smfmac_f32_32x32x32_bf16 v[160:175], v[224:227], v[32:39], v3
    v_exp_f32 v42, v42
    v_exp_f32 v43, v43
    v_exp_f32 v44, v44
    s_waitcnt vmcnt(3)
    v_mfma_f32_32x32x16_bf16 v[24:39], v[192:195], v[8:11], 0
    v_exp_f32 v45, v45
    v_exp_f32 v46, v46
    v_exp_f32 v47, v47
    v_exp_f32 v48, v48
    v_exp_f32 v49, v49
    v_exp_f32 v50, v50
    v_smfmac_f32_32x32x32_bf16 v[176:191], v[220:223], v[40:47], v3
    v_exp_f32 v51, v51
    v_exp_f32 v52, v52
    v_exp_f32 v53, v53
    v_exp_f32 v54, v54
    v_exp_f32 v55, v55
    v_exp_f32 v24, v24
    v_exp_f32 v25, v25
    v_smfmac_f32_32x32x32_bf16 v[176:191], v[224:227], v[48:55], v3
    v_exp_f32 v26, v26
    v_exp_f32 v27, v27
    v_exp_f32 v28, v28
    buffer_load_dwordx4 v[216:219], v252, s[56:59], s82 offen offset:0 sc1
    s_mov_b64 exec, s[70:71]
    buffer_load_dwordx4 v[220:223], v2, s[56:59], s82 offen offset:1024 sc1
    buffer_load_dwordx4 v[224:227], v2, s[56:59], s82 offen offset:1536 sc1
    s_mov_b64 exec, -1
    s_add_u32 s82, s82, 2048
    v_mfma_f32_32x32x16_bf16 v[40:55], v[192:195], v[12:15], 0
    v_exp_f32 v29, v29
    v_exp_f32 v30, v30
    v_exp_f32 v31, v31
    v_exp_f32 v32, v32
    v_exp_f32 v33, v33
    v_exp_f32 v34, v34
    v_smfmac_f32_32x32x32_bf16 v[128:143], v[196:199], v[24:31], v3
    v_exp_f32 v35, v35
    v_exp_f32 v36, v36
    v_exp_f32 v37, v37
    v_exp_f32 v38, v38
    v_exp_f32 v39, v39
    v_exp_f32 v40, v40
    v_exp_f32 v41, v41
    v_smfmac_f32_32x32x32_bf16 v[128:143], v[200:203], v[32:39], v3
    v_exp_f32 v42, v42
    v_exp_f32 v43, v43
    v_exp_f32 v44, v44
    v_mfma_f32_32x32x16_bf16 v[24:39], v[192:195], v[16:19], 0
    v_exp_f32 v45, v45
    v_exp_f32 v46, v46
    v_exp_f32 v47, v47
    v_exp_f32 v48, v48
    v_exp_f32 v49, v49
    v_exp_f32 v50, v50
    v_smfmac_f32_32x32x32_bf16 v[144:159], v[196:199], v[40:47], v3
    v_exp_f32 v51, v51
    v_exp_f32 v52, v52
    v_exp_f32 v53, v53
    v_exp_f32 v54, v54
    v_exp_f32 v55, v55
    v_exp_f32 v24, v24
    v_exp_f32 v25, v25
    v_smfmac_f32_32x32x32_bf16 v[144:159], v[200:203], v[48:55], v3
    v_exp_f32 v26, v26
    v_exp_f32 v27, v27
    v_exp_f32 v28, v28
    v_mfma_f32_32x32x16_bf16 v[40:55], v[192:195], v[20:23], 0
    v_exp_f32 v29, v29
    v_exp_f32 v30, v30
    v_exp_f32 v31, v31
    v_exp_f32 v32, v32
    v_exp_f32 v33, v33
    v_exp_f32 v34, v34
    v_smfmac_f32_32x32x32_bf16 v[160:175], v[196:199], v[24:31], v3
    v_exp_f32 v35, v35
    v_exp_f32 v36, v36
    v_exp_f32 v37, v37
    v_exp_f32 v38, v38
    v_exp_f32 v39, v39
    v_exp_f32 v40, v40
    v_exp_f32 v41, v41
    v_smfmac_f32_32x32x32_bf16 v[160:175], v[200:203], v[32:39], v3
    v_exp_f32 v42, v42
    v_exp_f32 v43, v43
    v_exp_f32 v44, v44
    s_waitcnt vmcnt(3)
    v_mfma_f32_32x32x16_bf16 v[24:39], v[204:207], v[8:11], 0
    v_exp_f32 v45, v45
    v_exp_f32 v46, v46
    v_exp_f32 v47, v47
    v_exp_f32 v48, v48
    v_exp_f32 v49, v49
    v_exp_f32 v50, v50
    v_smfmac_f32_32x32x32_bf16 v[176:191], v[196:199], v[40:47], v3
    v_exp_f32 v51, v51
    v_exp_f32 v52, v52
    v_exp_f32 v53, v53
    v_exp_f32 v54, v54
    v_exp_f32 v55, v55
    v_exp_f32 v24, v24
    v_exp_f32 v25, v25
    v_smfmac_f32_32x32x32_bf16 v[176:191], v[200:203], v[48:55], v3
    v_exp_f32 v26, v26
    v_exp_f32 v27, v27
    v_exp_f32 v28, v28
    v_mfma_f32_32x32x16_bf16 v[40:55], v[204:207], v[12:15], 0
    v_exp_f32 v29, v29
    v_exp_f32 v30, v30
    v_exp_f32 v31, v31
    v_exp_f32 v32, v32
    v_exp_f32 v33, v33
    s_and_b32 s73, s60, 1
    s_lshl_b32 s73, s73, 9
    s_sub_u32 s76, s95, s73
    s_and_b32 s74, s60, 3
    s_lshr_b32 s75, s60, 2
    v_lshrrev_b32 v14, 3, v0
    v_and_b32 v7, 7, v0
    v_lshlrev_b32 v7, 4, v7
    v_lshl_add_u32 v14, v14, 10, v7
    s_lshl3_add_u32 s78, s66, s60
    s_lshl_b32 s78, s78, 13
    s_lshl_b32 s79, s67, 7
    s_add_u32 s78, s78, s79
    buffer_load_dwordx4 v[60:63], v7, s[48:51], s79 offen offset:0
    buffer_load_dwordx4 v[56:59], v14, s[24:27], s78 offen offset:0
    v_exp_f32 v34, v34
    v_smfmac_f32_32x32x32_bf16 v[128:143], v[208:211], v[24:31], v3
    v_exp_f32 v35, v35
    v_lshlrev_b32 v8, 2, v0
    v_add_u32 v9, s99, v1
    v_add_u32 v10, s99, v8
    v_bfe_u32 v11, v0, 4, 1
    v_lshl_add_u32 v11, v11, 10, v2
    v_exp_f32 v36, v36
    v_exp_f32 v37, v37
    v_exp_f32 v38, v38
    v_exp_f32 v39, v39
    v_exp_f32 v40, v40
    v_exp_f32 v41, v41
    v_smfmac_f32_32x32x32_bf16 v[128:143], v[212:215], v[32:39], v3
    v_exp_f32 v42, v42
    v_exp_f32 v43, v43
    v_exp_f32 v44, v44
    v_mfma_f32_32x32x16_bf16 v[24:39], v[204:207], v[16:19], 0
    v_exp_f32 v45, v45
    v_exp_f32 v46, v46
    v_exp_f32 v47, v47
    v_exp_f32 v48, v48
    v_exp_f32 v49, v49
    v_exp_f32 v50, v50
    v_smfmac_f32_32x32x32_bf16 v[144:159], v[208:211], v[40:47], v3
    v_exp_f32 v51, v51
    v_exp_f32 v52, v52
    v_add_u32 v12, s96, v1
    v_add_u32 v13, s96, v8
    ds_write_b128 v12, v[128:131] offset:0
    ds_write_b128 v12, v[132:135] offset:1024
    ds_write_b32 v13, v136 offset:2048
    v_exp_f32 v53, v53
    v_exp_f32 v54, v54
    v_exp_f32 v55, v55
    v_exp_f32 v24, v24
    v_exp_f32 v25, v25
    v_smfmac_f32_32x32x32_bf16 v[144:159], v[212:215], v[48:55], v3
    v_exp_f32 v26, v26
    v_exp_f32 v27, v27
    v_exp_f32 v28, v28
    v_mfma_f32_32x32x16_bf16 v[40:55], v[204:207], v[20:23], 0
    v_exp_f32 v29, v29
    v_exp_f32 v30, v30
    v_exp_f32 v31, v31
    v_exp_f32 v32, v32
    v_exp_f32 v33, v33
    v_exp_f32 v34, v34
    v_smfmac_f32_32x32x32_bf16 v[160:175], v[208:211], v[24:31], v3
    v_exp_f32 v35, v35
    v_exp_f32 v36, v36
    v_add_u32 v12, s97, v1
    v_add_u32 v13, s97, v8
    ds_write_b128 v12, v[144:147] offset:2304
    ds_write_b128 v12, v[148:151] offset:3328
    ds_write_b32 v13, v152 offset:4352
    v_exp_f32 v37, v37
    v_exp_f32 v38, v38
    v_exp_f32 v39, v39
    v_exp_f32 v40, v40
    v_exp_f32 v41, v41
    v_smfmac_f32_32x32x32_bf16 v[160:175], v[212:215], v[32:39], v3
    v_exp_f32 v42, v42
    v_exp_f32 v43, v43
    v_exp_f32 v44, v44
    s_waitcnt vmcnt(2)
    v_mfma_f32_32x32x16_bf16 v[24:39], v[216:219], v[16:19], 0
    v_exp_f32 v45, v45
    v_exp_f32 v46, v46
    v_exp_f32 v47, v47
    v_exp_f32 v48, v48
    v_exp_f32 v49, v49
    v_exp_f32 v50, v50
    v_smfmac_f32_32x32x32_bf16 v[176:191], v[208:211], v[40:47], v3
    v_exp_f32 v51, v51
    v_exp_f32 v52, v52
    v_exp_f32 v53, v53
    v_exp_f32 v54, v54
    v_exp_f32 v55, v55
    v_exp_f32 v24, v24
    v_exp_f32 v25, v25
    v_smfmac_f32_32x32x32_bf16 v[176:191], v[212:215], v[48:55], v3
    v_exp_f32 v26, v26
    v_exp_f32 v27, v27
    v_exp_f32 v28, v28
    v_mfma_f32_32x32x16_bf16 v[40:55], v[216:219], v[20:23], 0
    v_exp_f32 v29, v29
    v_exp_f32 v30, v30
    v_exp_f32 v31, v31
    v_exp_f32 v32, v32
    v_exp_f32 v33, v33
    v_exp_f32 v34, v34
    v_smfmac_f32_32x32x32_bf16 v[160:175], v[220:223], v[24:31], v3
    v_exp_f32 v35, v35
    v_exp_f32 v36, v36
    v_exp_f32 v37, v37
    v_exp_f32 v38, v38
    v_exp_f32 v39, v39
    v_exp_f32 v40, v40
    v_exp_f32 v41, v41
    v_smfmac_f32_32x32x32_bf16 v[160:175], v[224:227], v[32:39], v3
    v_exp_f32 v42, v42
    v_exp_f32 v43, v43
    v_exp_f32 v44, v44
    v_exp_f32 v45, v45
    v_exp_f32 v46, v46
    v_exp_f32 v47, v47
    v_exp_f32 v48, v48
    v_exp_f32 v49, v49
    v_exp_f32 v50, v50
    v_smfmac_f32_32x32x32_bf16 v[176:191], v[220:223], v[40:47], v3
    v_exp_f32 v51, v51
    v_exp_f32 v52, v52
    v_add_u32 v12, s98, v1
    v_add_u32 v13, s98, v8
    ds_write_b128 v12, v[160:163] offset:4608
    ds_write_b128 v12, v[164:167] offset:5632
    ds_write_b32 v13, v168 offset:6656
    v_exp_f32 v53, v53
    v_exp_f32 v54, v54
    v_exp_f32 v55, v55
    s_nop 1
    v_smfmac_f32_32x32x32_bf16 v[176:191], v[224:227], v[48:55], v3
    s_waitcnt vmcnt(0)
L_att_done:
    s_setprio 0
    s_waitcnt lgkmcnt(0)
    s_barrier
    ds_read_b128 v[24:27], v9 offset:0
    ds_read_b128 v[28:31], v9 offset:1024
    ds_read_b32 v32, v10 offset:2048
    ds_read_b128 v[34:37], v9 offset:2304
    ds_read_b128 v[38:41], v9 offset:3328
    ds_read_b32 v42, v10 offset:4352
    ds_read_b128 v[44:47], v9 offset:4608
    ds_read_b128 v[48:51], v9 offset:5632
    ds_read_b32 v52, v10 offset:6656
    s_waitcnt lgkmcnt(6)
    v_pk_add_f32 v[176:177], v[176:177], v[24:25]
    v_pk_add_f32 v[178:179], v[178:179], v[26:27]
    v_pk_add_f32 v[180:181], v[180:181], v[28:29]
    v_pk_add_f32 v[182:183], v[182:183], v[30:31]
    v_add_f32 v184, v184, v32
    s_waitcnt lgkmcnt(3)
    v_pk_add_f32 v[176:177], v[176:177], v[34:35]
    v_pk_add_f32 v[178:179], v[178:179], v[36:37]
    v_pk_add_f32 v[180:181], v[180:181], v[38:39]
    v_pk_add_f32 v[182:183], v[182:183], v[40:41]
    v_add_f32 v184, v184, v42
    s_waitcnt lgkmcnt(0)
    v_pk_add_f32 v[176:177], v[176:177], v[44:45]
    v_pk_add_f32 v[178:179], v[178:179], v[46:47]
    v_pk_add_f32 v[180:181], v[180:181], v[48:49]
    v_pk_add_f32 v[182:183], v[182:183], v[50:51]
    v_add_f32 v184, v184, v52
    v_pk_mul_f32 v[12:13], v[176:177], 0 op_sel_hi:[1,0]
    v_pk_fma_f32 v[12:13], v[178:179], 0, v[12:13] op_sel_hi:[1,0,1]
    v_pk_fma_f32 v[12:13], v[180:181], 0, v[12:13] op_sel_hi:[1,0,1]
    v_pk_fma_f32 v[12:13], v[182:183], 0, v[12:13] op_sel_hi:[1,0,1]
    v_add_f32 v12, v12, v184
    v_add_f32 v12, v12, v13
    v_cmp_nle_f32 vcc, 0x30800000, v12
    s_nop 0
    s_mov_b64 s[72:73], vcc
    v_cmp_nge_f32 vcc, 0x5d800000, v12
    s_nop 0
    s_or_b64 s[72:73], s[72:73], vcc
    s_cbranch_scc1 L_slow
L_norm:
    v_rcp_f32 v12, v184
    s_nop 0
    v_pk_mul_f32 v[176:177], v[176:177], v[12:13] op_sel_hi:[1,0]
    v_pk_mul_f32 v[178:179], v[178:179], v[12:13] op_sel_hi:[1,0]
    v_pk_mul_f32 v[180:181], v[180:181], v[12:13] op_sel_hi:[1,0]
    v_pk_mul_f32 v[182:183], v[182:183], v[12:13] op_sel_hi:[1,0]
    v_cvt_pk_bf16_f32 v16, v176, v177
    v_cvt_pk_bf16_f32 v17, v178, v179
    v_cvt_pk_bf16_f32 v18, v180, v181
    v_cvt_pk_bf16_f32 v19, v182, v183
    v_and_b32 v16, -2, v16
    buffer_store_dwordx4 v[16:19], v11, s[56:59], s76 offen offset:0 sc1
    v_mov_b32 v2, v14
    v_lshrrev_b32 v3, 3, v0
    v_mul_u32_u24 v4, 144, v3
    s_mul_i32 s72, s60, 1152
    s_add_u32 s72, s72, 120832
    v_add3_u32 v4, v4, v7, s72
    ds_read_b128 v[64:67], v4 offset:0
    ds_read_b128 v[68:71], v4 offset:10240
    ds_read_b128 v[72:75], v4 offset:20480
    ds_read_b128 v[76:79], v4 offset:30720
    v_bfe_u32 v4, v0, 2, 2
    v_bfe_u32 v5, v0, 4, 1
    v_lshl_add_u32 v4, v5, 2, v4
    v_lshrrev_b32 v5, 1, v4
    v_lshlrev_b32 v92, 7, v4
    v_lshl_add_u32 v92, v5, 5, v92
    v_lshrrev_b32 v6, 5, v0
    v_lshl_add_u32 v92, v6, 11, v92
    v_and_b32 v4, 3, v0
    v_lshl_add_u32 v92, v4, 3, v92
    s_lshl_b32 s72, s75, 15
    v_add_u32 v92, s72, v92
    v_xor_b32 v93, 32, v92
    v_xor_b32 v94, 64, v92
    v_xor_b32 v95, 0x60, v92
    s_barrier
    s_cmp_eq_u32 s63, 1
    s_cbranch_scc1 L_tail_b
    ds_read_b64_tr_b16 v[128:129], v92 offset:0
    ds_read_b64_tr_b16 v[130:131], v92 offset:1024
    s_lshl2_add_u32 s72, s66, s74
    ds_read_b64_tr_b16 v[132:133], v93 offset:0
    ds_read_b64_tr_b16 v[134:135], v93 offset:1024
    s_lshr_b32 s76, s72, 1
    ds_read_b64_tr_b16 v[136:137], v94 offset:0
    ds_read_b64_tr_b16 v[138:139], v94 offset:1024
    s_lshl1_add_u32 s76, s76, s75
    ds_read_b64_tr_b16 v[140:141], v95 offset:0
    ds_read_b64_tr_b16 v[142:143], v95 offset:1024
    s_lshl_b32 s76, s76, 14
    ds_read_b64_tr_b16 v[144:145], v92 offset:4096
    ds_read_b64_tr_b16 v[146:147], v92 offset:5120
    s_and_b32 s72, s72, 1
    ds_read_b64_tr_b16 v[148:149], v93 offset:4096
    ds_read_b64_tr_b16 v[150:151], v93 offset:5120
    s_lshl_b32 s72, s72, 10
    ds_read_b64_tr_b16 v[152:153], v94 offset:4096
    ds_read_b64_tr_b16 v[154:155], v94 offset:5120
    s_add_u32 s76, s76, s72
    ds_read_b64_tr_b16 v[156:157], v95 offset:4096
    ds_read_b64_tr_b16 v[158:159], v95 offset:5120
    s_add_u32 s76, s76, 1048576
    ds_read_b64_tr_b16 v[160:161], v92 offset:8192
    ds_read_b64_tr_b16 v[162:163], v92 offset:9216
    s_add_u32 s77, s76, 0x1000
    ds_read_b64_tr_b16 v[164:165], v93 offset:8192
    ds_read_b64_tr_b16 v[166:167], v93 offset:9216
    s_add_u32 s80, s76, 0x2000
    ds_read_b64_tr_b16 v[168:169], v94 offset:8192
    ds_read_b64_tr_b16 v[170:171], v94 offset:9216
    s_add_u32 s81, s76, 0x3000
    ds_read_b64_tr_b16 v[172:173], v95 offset:8192
    ds_read_b64_tr_b16 v[174:175], v95 offset:9216
    v_mul_u32_u24 v3, 272, v3
    v_lshl_add_u32 v3, v7, 1, v3
    s_mul_i32 s72, s60, 2176
    s_add_u32 s72, s72, 65536
    v_add_u32 v3, s72, v3
    v_and_b32 v5, 15, v0
    v_mul_u32_u24 v5, 272, v5
    v_and_b32 v4, 48, v0
    s_mul_i32 s72, s60, 4352
    s_add_u32 s72, s72, 65536
    v_add3_u32 v5, v5, v4, s72
    s_mov_b32 s82, 0x3f80
    s_mov_b32 s83, 0x3f800000
    buffer_load_dwordx4 v[24:27], v1, s[56:59], s76 offen offset:0 sc1
    buffer_load_dwordx4 v[28:31], v1, s[56:59], s76 offen offset:2048 sc1
    buffer_load_dwordx4 v[32:35], v1, s[56:59], s77 offen offset:0 sc1
    buffer_load_dwordx4 v[36:39], v1, s[56:59], s77 offen offset:2048 sc1
    buffer_load_dwordx4 v[40:43], v1, s[56:59], s80 offen offset:0 sc1
    buffer_load_dwordx4 v[44:47], v1, s[56:59], s80 offen offset:2048 sc1
    buffer_load_dwordx4 v[48:51], v1, s[56:59], s81 offen offset:0 sc1
    buffer_load_dwordx4 v[52:55], v1, s[56:59], s81 offen offset:2048 sc1
    ds_read_b64_tr_b16 v[176:177], v92 offset:12288
    ds_read_b64_tr_b16 v[178:179], v92 offset:13312
    ds_read_b64_tr_b16 v[180:181], v93 offset:12288
    ds_read_b64_tr_b16 v[182:183], v93 offset:13312
    ds_read_b64_tr_b16 v[184:185], v94 offset:12288
    ds_read_b64_tr_b16 v[186:187], v94 offset:13312
    ds_read_b64_tr_b16 v[188:189], v95 offset:12288
    ds_read_b64_tr_b16 v[190:191], v95 offset:13312
    ds_read_b64_tr_b16 v[192:193], v92 offset:16384
    ds_read_b64_tr_b16 v[194:195], v92 offset:17408
    ds_read_b64_tr_b16 v[196:197], v93 offset:16384
    ds_read_b64_tr_b16 v[198:199], v93 offset:17408
    ds_read_b64_tr_b16 v[200:201], v94 offset:16384
    ds_read_b64_tr_b16 v[202:203], v94 offset:17408
    ds_read_b64_tr_b16 v[204:205], v95 offset:16384
    ds_read_b64_tr_b16 v[206:207], v95 offset:17408
    ds_read_b64_tr_b16 v[208:209], v92 offset:20480
    ds_read_b64_tr_b16 v[210:211], v92 offset:21504
    ds_read_b64_tr_b16 v[212:213], v93 offset:20480
    ds_read_b64_tr_b16 v[214:215], v93 offset:21504
    ds_read_b64_tr_b16 v[216:217], v94 offset:20480
    ds_read_b64_tr_b16 v[218:219], v94 offset:21504
    ds_read_b64_tr_b16 v[220:221], v95 offset:20480
    ds_read_b64_tr_b16 v[222:223], v95 offset:21504
    ds_read_b64_tr_b16 v[224:225], v92 offset:24576
    ds_read_b64_tr_b16 v[226:227], v92 offset:25600
    ds_read_b64_tr_b16 v[228:229], v93 offset:24576
    ds_read_b64_tr_b16 v[230:231], v93 offset:25600
    ds_read_b64_tr_b16 v[232:233], v94 offset:24576
    ds_read_b64_tr_b16 v[234:235], v94 offset:25600
    ds_read_b64_tr_b16 v[236:237], v95 offset:24576
    ds_read_b64_tr_b16 v[238:239], v95 offset:25600
    ds_read_b64_tr_b16 v[240:241], v92 offset:28672
    ds_read_b64_tr_b16 v[242:243], v92 offset:29696
    ds_read_b64_tr_b16 v[244:245], v93 offset:28672
    ds_read_b64_tr_b16 v[246:247], v93 offset:29696
    ds_read_b64_tr_b16 v[248:249], v94 offset:28672
    ds_read_b64_tr_b16 v[250:251], v94 offset:29696
    ds_read_b64_tr_b16 v[252:253], v95 offset:28672
    ds_read_b64_tr_b16 v[254:255], v95 offset:29696
    v_mov_b32 v96, 0
    v_mov_b32 v97, 0
    v_mov_b32 v98, 0
    v_mov_b32 v99, 0
    v_mov_b32 v100, 0
    v_mov_b32 v101, 0
    v_mov_b32 v102, 0
    v_mov_b32 v103, 0
    s_waitcnt lgkmcnt(15)
    v_dot2c_f32_bf16 v96, s82, v64
    v_dot2c_f32_bf16 v97, s83, v64
    v_dot2c_f32_bf16 v98, s82, v65
    v_dot2c_f32_bf16 v99, s83, v65
    v_dot2c_f32_bf16 v100, s82, v66
    v_dot2c_f32_bf16 v101, s83, v66
    v_dot2c_f32_bf16 v102, s82, v67
    v_dot2c_f32_bf16 v103, s83, v67
    v_dot2c_f32_bf16 v96, s82, v68
    v_dot2c_f32_bf16 v97, s83, v68
    v_dot2c_f32_bf16 v98, s82, v69
    v_dot2c_f32_bf16 v99, s83, v69
    v_dot2c_f32_bf16 v100, s82, v70
    v_dot2c_f32_bf16 v101, s83, v70
    v_dot2c_f32_bf16 v102, s82, v71
    v_dot2c_f32_bf16 v103, s83, v71
    v_dot2c_f32_bf16 v96, s82, v72
    v_dot2c_f32_bf16 v97, s83, v72
    v_dot2c_f32_bf16 v98, s82, v73
    v_dot2c_f32_bf16 v99, s83, v73
    v_dot2c_f32_bf16 v100, s82, v74
    v_dot2c_f32_bf16 v101, s83, v74
    v_dot2c_f32_bf16 v102, s82, v75
    v_dot2c_f32_bf16 v103, s83, v75
    v_dot2c_f32_bf16 v96, s82, v76
    v_dot2c_f32_bf16 v97, s83, v76
    v_dot2c_f32_bf16 v98, s82, v77
    v_dot2c_f32_bf16 v99, s83, v77
    v_dot2c_f32_bf16 v100, s82, v78
    v_dot2c_f32_bf16 v101, s83, v78
    v_dot2c_f32_bf16 v102, s82, v79
    v_dot2c_f32_bf16 v103, s83, v79
    v_dot2c_f32_bf16 v96, s82, v60
    v_dot2c_f32_bf16 v97, s83, v60
    v_dot2c_f32_bf16 v98, s82, v61
    v_dot2c_f32_bf16 v99, s83, v61
    v_dot2c_f32_bf16 v100, s82, v62
    v_dot2c_f32_bf16 v101, s83, v62
    v_dot2c_f32_bf16 v102, s82, v63
    v_dot2c_f32_bf16 v103, s83, v63
    v_lshlrev_b32 v104, 16, v56
    v_and_b32 v105, s89, v56
    v_lshlrev_b32 v106, 16, v57
    v_and_b32 v107, s89, v57
    v_lshlrev_b32 v108, 16, v58
    v_and_b32 v109, s89, v58
    v_lshlrev_b32 v110, 16, v59
    v_and_b32 v111, s89, v59
    v_mul_f32 v64, 0xbfb8aa3b, v96
    v_mul_f32 v65, 0xbfb8aa3b, v97
    v_mul_f32 v66, 0xbfb8aa3b, v98
    v_mul_f32 v67, 0xbfb8aa3b, v99
    v_mul_f32 v68, 0xbfb8aa3b, v100
    v_mul_f32 v69, 0xbfb8aa3b, v101
    v_mul_f32 v70, 0xbfb8aa3b, v102
    v_mul_f32 v71, 0xbfb8aa3b, v103
    v_exp_f32 v64, v64
    v_exp_f32 v65, v65
    v_exp_f32 v66, v66
    v_exp_f32 v67, v67
    v_exp_f32 v68, v68
    v_exp_f32 v69, v69
    v_exp_f32 v70, v70
    v_exp_f32 v71, v71
    v_add_f32 v64, 1.0, v64
    v_add_f32 v65, 1.0, v65
    v_add_f32 v66, 1.0, v66
    v_add_f32 v67, 1.0, v67
    v_add_f32 v68, 1.0, v68
    v_add_f32 v69, 1.0, v69
    v_add_f32 v70, 1.0, v70
    v_add_f32 v71, 1.0, v71
    v_rcp_f32 v64, v64
    v_rcp_f32 v65, v65
    v_rcp_f32 v66, v66
    v_rcp_f32 v67, v67
    v_rcp_f32 v68, v68
    v_rcp_f32 v69, v69
    v_rcp_f32 v70, v70
    v_rcp_f32 v71, v71
    v_mul_f32 v96, v96, v64
    v_mul_f32 v97, v97, v65
    v_mul_f32 v98, v98, v66
    v_mul_f32 v99, v99, v67
    v_mul_f32 v100, v100, v68
    v_mul_f32 v101, v101, v69
    v_mul_f32 v102, v102, v70
    v_mul_f32 v103, v103, v71
    s_branch L_tail_j
L_tail_b:
    s_lshl2_add_u32 s72, s66, s74
    s_lshr_b32 s76, s72, 1
    s_lshl1_add_u32 s76, s76, s75
    s_lshl_b32 s76, s76, 14
    s_and_b32 s72, s72, 1
    s_lshl_b32 s72, s72, 10
    s_add_u32 s76, s76, s72
    s_add_u32 s76, s76, 1048576
    s_add_u32 s77, s76, 0x1000
    s_add_u32 s80, s76, 0x2000
    s_add_u32 s81, s76, 0x3000
    v_mul_u32_u24 v3, 272, v3
    v_lshl_add_u32 v3, v7, 1, v3
    s_mul_i32 s72, s60, 2176
    s_add_u32 s72, s72, 65536
    v_add_u32 v3, s72, v3
    v_and_b32 v5, 15, v0
    v_mul_u32_u24 v5, 272, v5
    v_and_b32 v4, 48, v0
    s_mul_i32 s72, s60, 4352
    s_add_u32 s72, s72, 65536
    v_add3_u32 v5, v5, v4, s72
    s_mov_b32 s82, 0x3f80
    s_mov_b32 s83, 0x3f800000
    v_mov_b32 v96, 0
    v_mov_b32 v97, 0
    v_mov_b32 v98, 0
    v_mov_b32 v99, 0
    v_mov_b32 v100, 0
    v_mov_b32 v101, 0
    v_mov_b32 v102, 0
    v_mov_b32 v103, 0
    s_waitcnt lgkmcnt(0)
    v_dot2c_f32_bf16 v96, s82, v64
    v_dot2c_f32_bf16 v97, s83, v64
    v_dot2c_f32_bf16 v98, s82, v65
    v_dot2c_f32_bf16 v99, s83, v65
    v_dot2c_f32_bf16 v100, s82, v66
    v_dot2c_f32_bf16 v101, s83, v66
    v_dot2c_f32_bf16 v102, s82, v67
    v_dot2c_f32_bf16 v103, s83, v67
    v_dot2c_f32_bf16 v96, s82, v68
    v_dot2c_f32_bf16 v97, s83, v68
    v_dot2c_f32_bf16 v98, s82, v69
    v_dot2c_f32_bf16 v99, s83, v69
    v_dot2c_f32_bf16 v100, s82, v70
    v_dot2c_f32_bf16 v101, s83, v70
    v_dot2c_f32_bf16 v102, s82, v71
    v_dot2c_f32_bf16 v103, s83, v71
    v_dot2c_f32_bf16 v96, s82, v72
    v_dot2c_f32_bf16 v97, s83, v72
    v_dot2c_f32_bf16 v98, s82, v73
    v_dot2c_f32_bf16 v99, s83, v73
    v_dot2c_f32_bf16 v100, s82, v74
    v_dot2c_f32_bf16 v101, s83, v74
    v_dot2c_f32_bf16 v102, s82, v75
    v_dot2c_f32_bf16 v103, s83, v75
    v_dot2c_f32_bf16 v96, s82, v76
    v_dot2c_f32_bf16 v97, s83, v76
    v_dot2c_f32_bf16 v98, s82, v77
    v_dot2c_f32_bf16 v99, s83, v77
    v_dot2c_f32_bf16 v100, s82, v78
    v_dot2c_f32_bf16 v101, s83, v78
    v_dot2c_f32_bf16 v102, s82, v79
    v_dot2c_f32_bf16 v103, s83, v79
    v_dot2c_f32_bf16 v96, s82, v60
    v_dot2c_f32_bf16 v97, s83, v60
    v_dot2c_f32_bf16 v98, s82, v61
    v_dot2c_f32_bf16 v99, s83, v61
    v_dot2c_f32_bf16 v100, s82, v62
    v_dot2c_f32_bf16 v101, s83, v62
    v_dot2c_f32_bf16 v102, s82, v63
    v_dot2c_f32_bf16 v103, s83, v63
    v_lshlrev_b32 v104, 16, v56
    v_and_b32 v105, s89, v56
    v_lshlrev_b32 v106, 16, v57
    v_and_b32 v107, s89, v57
    v_lshlrev_b32 v108, 16, v58
    v_and_b32 v109, s89, v58
    v_lshlrev_b32 v110, 16, v59
    v_and_b32 v111, s89, v59
    v_mul_f32 v64, 0xbfb8aa3b, v96
    v_mul_f32 v65, 0xbfb8aa3b, v97
    v_mul_f32 v66, 0xbfb8aa3b, v98
    v_mul_f32 v67, 0xbfb8aa3b, v99
    v_mul_f32 v68, 0xbfb8aa3b, v100
    v_mul_f32 v69, 0xbfb8aa3b, v101
    v_mul_f32 v70, 0xbfb8aa3b, v102
    v_mul_f32 v71, 0xbfb8aa3b, v103
    v_exp_f32 v64, v64
    v_exp_f32 v65, v65
    v_exp_f32 v66, v66
    v_exp_f32 v67, v67
    v_exp_f32 v68, v68
    v_exp_f32 v69, v69
    v_exp_f32 v70, v70
    v_exp_f32 v71, v71
    v_add_f32 v64, 1.0, v64
    v_add_f32 v65, 1.0, v65
    v_add_f32 v66, 1.0, v66
    v_add_f32 v67, 1.0, v67
    v_add_f32 v68, 1.0, v68
    v_add_f32 v69, 1.0, v69
    v_add_f32 v70, 1.0, v70
    v_add_f32 v71, 1.0, v71
    v_rcp_f32 v64, v64
    v_rcp_f32 v65, v65
    v_rcp_f32 v66, v66
    v_rcp_f32 v67, v67
    v_rcp_f32 v68, v68
    v_rcp_f32 v69, v69
    v_rcp_f32 v70, v70
    v_rcp_f32 v71, v71
    v_mul_f32 v96, v96, v64
    v_mul_f32 v97, v97, v65
    v_mul_f32 v98, v98, v66
    v_mul_f32 v99, v99, v67
    v_mul_f32 v100, v100, v68
    v_mul_f32 v101, v101, v69
    v_mul_f32 v102, v102, v70
    v_mul_f32 v103, v103, v71
    ds_read_b64_tr_b16 v[128:129], v92 offset:0
    ds_read_b64_tr_b16 v[130:131], v92 offset:1024
    ds_read_b64_tr_b16 v[132:133], v93 offset:0
    ds_read_b64_tr_b16 v[134:135], v93 offset:1024
    ds_read_b64_tr_b16 v[136:137], v94 offset:0
    ds_read_b64_tr_b16 v[138:139], v94 offset:1024
    ds_read_b64_tr_b16 v[140:141], v95 offset:0
    ds_read_b64_tr_b16 v[142:143], v95 offset:1024
    ds_read_b64_tr_b16 v[144:145], v92 offset:4096
    ds_read_b64_tr_b16 v[146:147], v92 offset:5120
    ds_read_b64_tr_b16 v[148:149], v93 offset:4096
    ds_read_b64_tr_b16 v[150:151], v93 offset:5120
    ds_read_b64_tr_b16 v[152:153], v94 offset:4096
    ds_read_b64_tr_b16 v[154:155], v94 offset:5120
    ds_read_b64_tr_b16 v[156:157], v95 offset:4096
    ds_read_b64_tr_b16 v[158:159], v95 offset:5120
    ds_read_b64_tr_b16 v[160:161], v92 offset:8192
    ds_read_b64_tr_b16 v[162:163], v92 offset:9216
    ds_read_b64_tr_b16 v[164:165], v93 offset:8192
    ds_read_b64_tr_b16 v[166:167], v93 offset:9216
    ds_read_b64_tr_b16 v[168:169], v94 offset:8192
    ds_read_b64_tr_b16 v[170:171], v94 offset:9216
    ds_read_b64_tr_b16 v[172:173], v95 offset:8192
    ds_read_b64_tr_b16 v[174:175], v95 offset:9216
    buffer_load_dwordx4 v[24:27], v1, s[56:59], s76 offen offset:0 sc1
    buffer_load_dwordx4 v[28:31], v1, s[56:59], s76 offen offset:2048 sc1
    buffer_load_dwordx4 v[32:35], v1, s[56:59], s77 offen offset:0 sc1
    buffer_load_dwordx4 v[36:39], v1, s[56:59], s77 offen offset:2048 sc1
    buffer_load_dwordx4 v[40:43], v1, s[56:59], s80 offen offset:0 sc1
    buffer_load_dwordx4 v[44:47], v1, s[56:59], s80 offen offset:2048 sc1
    buffer_load_dwordx4 v[48:51], v1, s[56:59], s81 offen offset:0 sc1
    buffer_load_dwordx4 v[52:55], v1, s[56:59], s81 offen offset:2048 sc1
    ds_read_b64_tr_b16 v[176:177], v92 offset:12288
    ds_read_b64_tr_b16 v[178:179], v92 offset:13312
    ds_read_b64_tr_b16 v[180:181], v93 offset:12288
    ds_read_b64_tr_b16 v[182:183], v93 offset:13312
    ds_read_b64_tr_b16 v[184:185], v94 offset:12288
    ds_read_b64_tr_b16 v[186:187], v94 offset:13312
    ds_read_b64_tr_b16 v[188:189], v95 offset:12288
    ds_read_b64_tr_b16 v[190:191], v95 offset:13312
    ds_read_b64_tr_b16 v[192:193], v92 offset:16384
    ds_read_b64_tr_b16 v[194:195], v92 offset:17408
    ds_read_b64_tr_b16 v[196:197], v93 offset:16384
    ds_read_b64_tr_b16 v[198:199], v93 offset:17408
    ds_read_b64_tr_b16 v[200:201], v94 offset:16384
    ds_read_b64_tr_b16 v[202:203], v94 offset:17408
    ds_read_b64_tr_b16 v[204:205], v95 offset:16384
    ds_read_b64_tr_b16 v[206:207], v95 offset:17408
    ds_read_b64_tr_b16 v[208:209], v92 offset:20480
    ds_read_b64_tr_b16 v[210:211], v92 offset:21504
    ds_read_b64_tr_b16 v[212:213], v93 offset:20480
    ds_read_b64_tr_b16 v[214:215], v93 offset:21504
    ds_read_b64_tr_b16 v[216:217], v94 offset:20480
    ds_read_b64_tr_b16 v[218:219], v94 offset:21504
    ds_read_b64_tr_b16 v[220:221], v95 offset:20480
    ds_read_b64_tr_b16 v[222:223], v95 offset:21504
    ds_read_b64_tr_b16 v[224:225], v92 offset:24576
    ds_read_b64_tr_b16 v[226:227], v92 offset:25600
    ds_read_b64_tr_b16 v[228:229], v93 offset:24576
    ds_read_b64_tr_b16 v[230:231], v93 offset:25600
    ds_read_b64_tr_b16 v[232:233], v94 offset:24576
    ds_read_b64_tr_b16 v[234:235], v94 offset:25600
    ds_read_b64_tr_b16 v[236:237], v95 offset:24576
    ds_read_b64_tr_b16 v[238:239], v95 offset:25600
    ds_read_b64_tr_b16 v[240:241], v92 offset:28672
    ds_read_b64_tr_b16 v[242:243], v92 offset:29696
    ds_read_b64_tr_b16 v[244:245], v93 offset:28672
    ds_read_b64_tr_b16 v[246:247], v93 offset:29696
    ds_read_b64_tr_b16 v[248:249], v94 offset:28672
    ds_read_b64_tr_b16 v[250:251], v94 offset:29696
    ds_read_b64_tr_b16 v[252:253], v95 offset:28672
    ds_read_b64_tr_b16 v[254:255], v95 offset:29696
L_tail_j:
    s_mov_b32 s73, 0
    s_waitcnt lgkmcnt(0)
L_wo_0:
    s_waitcnt vmcnt(7)
    v_and_b32 v6, 1, v24
    v_cmp_ne_u32 vcc, 0, v6
    s_cbranch_vccnz L_oretry_0
L_ogo_0:
    v_mfma_f32_16x16x32_bf16 v[8:11], v[128:131], v[24:27], 0
    v_mfma_f32_16x16x32_bf16 v[12:15], v[132:135], v[24:27], 0
    v_mfma_f32_16x16x32_bf16 v[16:19], v[136:139], v[24:27], 0
    v_mfma_f32_16x16x32_bf16 v[20:23], v[140:143], v[24:27], 0
L_wo_1:
    s_waitcnt vmcnt(6)
    v_and_b32 v6, 1, v28
    v_cmp_ne_u32 vcc, 0, v6
    s_cbranch_vccnz L_oretry_1
L_ogo_1:
    v_mfma_f32_16x16x32_bf16 v[8:11], v[144:147], v[28:31], v[8:11]
    v_mfma_f32_16x16x32_bf16 v[12:15], v[148:151], v[28:31], v[12:15]
    v_mfma_f32_16x16x32_bf16 v[16:19], v[152:155], v[28:31], v[16:19]
    v_mfma_f32_16x16x32_bf16 v[20:23], v[156:159], v[28:31], v[20:23]
L_wo_2:
    s_waitcnt vmcnt(5)
    v_and_b32 v6, 1, v32
    v_cmp_ne_u32 vcc, 0, v6
    s_cbranch_vccnz L_oretry_2
L_ogo_2:
    v_mfma_f32_16x16x32_bf16 v[8:11], v[160:163], v[32:35], v[8:11]
    v_mfma_f32_16x16x32_bf16 v[12:15], v[164:167], v[32:35], v[12:15]
    v_mfma_f32_16x16x32_bf16 v[16:19], v[168:171], v[32:35], v[16:19]
    v_mfma_f32_16x16x32_bf16 v[20:23], v[172:175], v[32:35], v[20:23]
L_wo_3:
    s_waitcnt vmcnt(4)
    v_and_b32 v6, 1, v36
    v_cmp_ne_u32 vcc, 0, v6
    s_cbranch_vccnz L_oretry_3
L_ogo_3:
    v_mfma_f32_16x16x32_bf16 v[8:11], v[176:179], v[36:39], v[8:11]
    v_mfma_f32_16x16x32_bf16 v[12:15], v[180:183], v[36:39], v[12:15]
    v_mfma_f32_16x16x32_bf16 v[16:19], v[184:187], v[36:39], v[16:19]
    v_mfma_f32_16x16x32_bf16 v[20:23], v[188:191], v[36:39], v[20:23]
L_wo_4:
    s_waitcnt vmcnt(3)
    v_and_b32 v6, 1, v40
    v_cmp_ne_u32 vcc, 0, v6
    s_cbranch_vccnz L_oretry_4
L_ogo_4:
    v_mfma_f32_16x16x32_bf16 v[8:11], v[192:195], v[40:43], v[8:11]
    v_mfma_f32_16x16x32_bf16 v[12:15], v[196:199], v[40:43], v[12:15]
    v_mfma_f32_16x16x32_bf16 v[16:19], v[200:203], v[40:43], v[16:19]
    v_mfma_f32_16x16x32_bf16 v[20:23], v[204:207], v[40:43], v[20:23]
L_wo_5:
    s_waitcnt vmcnt(2)
    v_and_b32 v6, 1, v44
    v_cmp_ne_u32 vcc, 0, v6
    s_cbranch_vccnz L_oretry_5
L_ogo_5:
    v_mfma_f32_16x16x32_bf16 v[8:11], v[208:211], v[44:47], v[8:11]
    v_mfma_f32_16x16x32_bf16 v[12:15], v[212:215], v[44:47], v[12:15]
    v_mfma_f32_16x16x32_bf16 v[16:19], v[216:219], v[44:47], v[16:19]
    v_mfma_f32_16x16x32_bf16 v[20:23], v[220:223], v[44:47], v[20:23]
L_wo_6:
    s_waitcnt vmcnt(1)
    v_and_b32 v6, 1, v48
    v_cmp_ne_u32 vcc, 0, v6
    s_cbranch_vccnz L_oretry_6
L_ogo_6:
    v_mfma_f32_16x16x32_bf16 v[8:11], v[224:227], v[48:51], v[8:11]
    v_mfma_f32_16x16x32_bf16 v[12:15], v[228:231], v[48:51], v[12:15]
    v_mfma_f32_16x16x32_bf16 v[16:19], v[232:235], v[48:51], v[16:19]
    v_mfma_f32_16x16x32_bf16 v[20:23], v[236:239], v[48:51], v[20:23]
L_wo_7:
    s_waitcnt vmcnt(0)
    v_and_b32 v6, 1, v52
    v_cmp_ne_u32 vcc, 0, v6
    s_cbranch_vccnz L_oretry_7
L_ogo_7:
    v_mfma_f32_16x16x32_bf16 v[8:11], v[240:243], v[52:55], v[8:11]
    v_mfma_f32_16x16x32_bf16 v[12:15], v[244:247], v[52:55], v[12:15]
    v_mfma_f32_16x16x32_bf16 v[16:19], v[248:251], v[52:55], v[16:19]
    v_mfma_f32_16x16x32_bf16 v[20:23], v[252:255], v[52:55], v[20:23]
    s_nop 4
    ds_write_b128 v5, v[8:11] offset:0
    ds_write_b128 v5, v[12:15] offset:64
    ds_write_b128 v5, v[16:19] offset:128
    ds_write_b128 v5, v[20:23] offset:192
    s_waitcnt lgkmcnt(0)
    s_barrier
    ds_read_b128 v[112:115], v3 offset:0
    ds_read_b128 v[120:123], v3 offset:17408
    ds_read_b128 v[116:119], v3 offset:16
    ds_read_b128 v[124:127], v3 offset:17424
    s_waitcnt lgkmcnt(2)
    v_pk_add_f32 v[112:113], v[112:113], v[120:121]
    v_pk_add_f32 v[114:115], v[114:115], v[122:123]
    v_pk_fma_f32 v[112:113], v[112:113], v[96:97], v[104:105]
    v_pk_fma_f32 v[114:115], v[114:115], v[98:99], v[106:107]
    v_cvt_pk_bf16_f32 v64, v112, v113
    v_cvt_pk_bf16_f32 v65, v114, v115
    s_waitcnt lgkmcnt(0)
    v_pk_add_f32 v[116:117], v[116:117], v[124:125]
    v_pk_add_f32 v[118:119], v[118:119], v[126:127]
    v_pk_fma_f32 v[116:117], v[116:117], v[100:101], v[108:109]
    v_pk_fma_f32 v[118:119], v[118:119], v[102:103], v[110:111]
    v_cvt_pk_bf16_f32 v66, v116, v117
    v_cvt_pk_bf16_f32 v67, v118, v119
    buffer_store_dwordx4 v[64:67], v2, s[52:55], s78 offen offset:0 sc1
    s_or_b32 s72, s2, s60
    s_cmp_lg_u32 s72, 0
    s_cbranch_scc1 L_noepoch
    v_mov_b32 v7, s68
    s_mov_b64 exec, 1
    buffer_store_dword v7, v1, s[56:59], 0 offen offset:0 sc0 sc1
    s_mov_b64 exec, -1
L_noepoch:
L_end:
    s_endpgm
L_oretry_0:
    s_add_u32 s73, s73, 1
    s_cmp_ge_u32 s73, 262144
    s_cbranch_scc1 L_ogo_0
    s_waitcnt vmcnt(0)
    buffer_load_dwordx4 v[24:27], v1, s[56:59], s76 offen offset:0 sc1
    buffer_load_dwordx4 v[28:31], v1, s[56:59], s76 offen offset:2048 sc1
    buffer_load_dwordx4 v[32:35], v1, s[56:59], s77 offen offset:0 sc1
    buffer_load_dwordx4 v[36:39], v1, s[56:59], s77 offen offset:2048 sc1
    buffer_load_dwordx4 v[40:43], v1, s[56:59], s80 offen offset:0 sc1
    buffer_load_dwordx4 v[44:47], v1, s[56:59], s80 offen offset:2048 sc1
    buffer_load_dwordx4 v[48:51], v1, s[56:59], s81 offen offset:0 sc1
    buffer_load_dwordx4 v[52:55], v1, s[56:59], s81 offen offset:2048 sc1
    s_branch L_wo_0
L_oretry_1:
    s_add_u32 s73, s73, 1
    s_cmp_ge_u32 s73, 262144
    s_cbranch_scc1 L_ogo_1
    s_waitcnt vmcnt(0)
    buffer_load_dwordx4 v[28:31], v1, s[56:59], s76 offen offset:2048 sc1
    buffer_load_dwordx4 v[32:35], v1, s[56:59], s77 offen offset:0 sc1
    buffer_load_dwordx4 v[36:39], v1, s[56:59], s77 offen offset:2048 sc1
    buffer_load_dwordx4 v[40:43], v1, s[56:59], s80 offen offset:0 sc1
    buffer_load_dwordx4 v[44:47], v1, s[56:59], s80 offen offset:2048 sc1
    buffer_load_dwordx4 v[48:51], v1, s[56:59], s81 offen offset:0 sc1
    buffer_load_dwordx4 v[52:55], v1, s[56:59], s81 offen offset:2048 sc1
    s_branch L_wo_1
L_oretry_2:
    s_add_u32 s73, s73, 1
    s_cmp_ge_u32 s73, 262144
    s_cbranch_scc1 L_ogo_2
    s_waitcnt vmcnt(0)
    buffer_load_dwordx4 v[32:35], v1, s[56:59], s77 offen offset:0 sc1
    buffer_load_dwordx4 v[36:39], v1, s[56:59], s77 offen offset:2048 sc1
    buffer_load_dwordx4 v[40:43], v1, s[56:59], s80 offen offset:0 sc1
    buffer_load_dwordx4 v[44:47], v1, s[56:59], s80 offen offset:2048 sc1
    buffer_load_dwordx4 v[48:51], v1, s[56:59], s81 offen offset:0 sc1
    buffer_load_dwordx4 v[52:55], v1, s[56:59], s81 offen offset:2048 sc1
    s_branch L_wo_2
L_oretry_3:
    s_add_u32 s73, s73, 1
    s_cmp_ge_u32 s73, 262144
    s_cbranch_scc1 L_ogo_3
    s_waitcnt vmcnt(0)
    buffer_load_dwordx4 v[36:39], v1, s[56:59], s77 offen offset:2048 sc1
    buffer_load_dwordx4 v[40:43], v1, s[56:59], s80 offen offset:0 sc1
    buffer_load_dwordx4 v[44:47], v1, s[56:59], s80 offen offset:2048 sc1
    buffer_load_dwordx4 v[48:51], v1, s[56:59], s81 offen offset:0 sc1
    buffer_load_dwordx4 v[52:55], v1, s[56:59], s81 offen offset:2048 sc1
    s_branch L_wo_3
L_oretry_4:
    s_add_u32 s73, s73, 1
    s_cmp_ge_u32 s73, 262144
    s_cbranch_scc1 L_ogo_4
    s_waitcnt vmcnt(0)
    buffer_load_dwordx4 v[40:43], v1, s[56:59], s80 offen offset:0 sc1
    buffer_load_dwordx4 v[44:47], v1, s[56:59], s80 offen offset:2048 sc1
    buffer_load_dwordx4 v[48:51], v1, s[56:59], s81 offen offset:0 sc1
    buffer_load_dwordx4 v[52:55], v1, s[56:59], s81 offen offset:2048 sc1
    s_branch L_wo_4
L_oretry_5:
    s_add_u32 s73, s73, 1
    s_cmp_ge_u32 s73, 262144
    s_cbranch_scc1 L_ogo_5
    s_waitcnt vmcnt(0)
    buffer_load_dwordx4 v[44:47], v1, s[56:59], s80 offen offset:2048 sc1
    buffer_load_dwordx4 v[48:51], v1, s[56:59], s81 offen offset:0 sc1
    buffer_load_dwordx4 v[52:55], v1, s[56:59], s81 offen offset:2048 sc1
    s_branch L_wo_5
L_oretry_6:
    s_add_u32 s73, s73, 1
    s_cmp_ge_u32 s73, 262144
    s_cbranch_scc1 L_ogo_6
    s_waitcnt vmcnt(0)
    buffer_load_dwordx4 v[48:51], v1, s[56:59], s81 offen offset:0 sc1
    buffer_load_dwordx4 v[52:55], v1, s[56:59], s81 offen offset:2048 sc1
    s_branch L_wo_6
L_oretry_7:
    s_add_u32 s73, s73, 1
    s_cmp_ge_u32 s73, 262144
    s_cbranch_scc1 L_ogo_7
    s_waitcnt vmcnt(0)
    buffer_load_dwordx4 v[52:55], v1, s[56:59], s81 offen offset:2048 sc1
    s_branch L_wo_7
L_poll_h:
    s_mov_b32 s73, 0
L_poll2_h:
    s_sleep 6
    v_and_b32 v7, 31, v0
    v_lshlrev_b32 v7, 4, v7
    buffer_load_dword v7, v7, s[56:59], s87 offen offset:0 sc0 sc1
    s_add_u32 s73, s73, 1
    s_waitcnt vmcnt(0)
    s_cmp_ge_u32 s73, 262144
    s_cbranch_scc1 L_polled_h
    v_cmp_ne_u32 vcc, s68, v7
    s_cbranch_vccnz L_poll2_h
    s_branch L_polled_h
L_poll_q:
    s_mov_b32 s73, 0
L_poll2_q:
    s_sleep 6
    v_and_b32 v7, 31, v0
    v_lshlrev_b32 v7, 4, v7
    buffer_load_dword v7, v7, s[56:59], s79 offen offset:0 sc0 sc1
    s_add_u32 s73, s73, 1
    s_waitcnt vmcnt(0)
    s_cmp_ge_u32 s73, 262144
    s_cbranch_scc1 L_polled_q
    v_cmp_ne_u32 vcc, s68, v7
    s_cbranch_vccnz L_poll2_q
    s_branch L_polled_q
L_slow:
    s_waitcnt vmcnt(0)
    v_mov_b32 v13, 0xff800000
    s_mov_b32 s82, s83
    s_mov_b32 s81, 64
L_slow1:
    buffer_load_dwordx4 v[192:195], v252, s[56:59], s82 offen offset:0 sc1
    s_add_u32 s82, s82, 2048
    s_waitcnt vmcnt(0)
    v_mfma_f32_32x32x16_bf16 v[24:39], v[192:195], v[20:23], 0
    s_nop 11
    v_max3_f32 v13, v13, v24, v25
    v_max3_f32 v13, v13, v26, v27
    v_max3_f32 v13, v13, v28, v29
    v_max3_f32 v13, v13, v30, v31
    v_max3_f32 v13, v13, v32, v33
    v_max3_f32 v13, v13, v34, v35
    v_max3_f32 v13, v13, v36, v37
    v_max3_f32 v13, v13, v38, v39
    s_sub_u32 s81, s81, 1
    s_cmp_lg_u32 s81, 0
    s_cbranch_scc1 L_slow1
    v_mov_b32 v15, v13
    s_nop 1
    v_permlane32_swap_b32 v15, v13
    v_max_f32 v13, v15, v13
    v_sub_f32 v40, 0, v13
    v_mov_b32 v176, 0
    v_sub_f32 v41, 0, v13
    v_mov_b32 v177, 0
    v_sub_f32 v42, 0, v13
    v_mov_b32 v178, 0
    v_sub_f32 v43, 0, v13
    v_mov_b32 v179, 0
    v_sub_f32 v44, 0, v13
    v_mov_b32 v180, 0
    v_sub_f32 v45, 0, v13
    v_mov_b32 v181, 0
    v_sub_f32 v46, 0, v13
    v_mov_b32 v182, 0
    v_sub_f32 v47, 0, v13
    v_mov_b32 v183, 0
    v_sub_f32 v48, 0, v13
    v_mov_b32 v184, 0
    v_sub_f32 v49, 0, v13
    v_mov_b32 v185, 0
    v_sub_f32 v50, 0, v13
    v_mov_b32 v186, 0
    v_sub_f32 v51, 0, v13
    v_mov_b32 v187, 0
    v_sub_f32 v52, 0, v13
    v_mov_b32 v188, 0
    v_sub_f32 v53, 0, v13
    v_mov_b32 v189, 0
    v_sub_f32 v54, 0, v13
    v_mov_b32 v190, 0
    v_sub_f32 v55, 0, v13
    v_mov_b32 v191, 0
    s_mov_b32 s82, s83
    s_mov_b32 s81, 64
L_slow2:
    buffer_load_dwordx4 v[192:195], v252, s[56:59], s82 offen offset:0 sc1
    s_mov_b64 exec, s[70:71]
    buffer_load_dwordx4 v[196:199], v2, s[56:59], s82 offen offset:1024 sc1
    buffer_load_dwordx4 v[200:203], v2, s[56:59], s82 offen offset:1536 sc1
    s_mov_b64 exec, -1
    s_add_u32 s82, s82, 2048
    s_waitcnt vmcnt(0)
    v_mfma_f32_32x32x16_bf16 v[24:39], v[192:195], v[20:23], v[40:55]
    s_nop 11
    v_exp_f32 v24, v24
    v_exp_f32 v25, v25
    v_exp_f32 v26, v26
    v_exp_f32 v27, v27
    v_exp_f32 v28, v28
    v_exp_f32 v29, v29
    v_exp_f32 v30, v30
    v_exp_f32 v31, v31
    v_exp_f32 v32, v32
    v_exp_f32 v33, v33
    v_exp_f32 v34, v34
    v_exp_f32 v35, v35
    v_exp_f32 v36, v36
    v_exp_f32 v37, v37
    v_exp_f32 v38, v38
    v_exp_f32 v39, v39
    v_smfmac_f32_32x32x32_bf16 v[176:191], v[196:199], v[24:31], v3
    s_nop 0
    v_smfmac_f32_32x32x32_bf16 v[176:191], v[200:203], v[32:39], v3
    s_sub_u32 s81, s81, 1
    s_cmp_lg_u32 s81, 0
    s_cbranch_scc1 L_slow2
    s_nop 7
    s_branch L_norm
L_code_end:
    s_endpgm
.section .rodata,"a"
.p2align 6
.amdhsa_kernel recurrent_scan__softmax_full_mha__dense_activation_squared_relu__prompt_kernel
  .amdhsa_next_free_vgpr 256
  .amdhsa_next_free_sgpr 102
  .amdhsa_accum_offset 256
  .amdhsa_group_segment_fixed_size 0
  .amdhsa_kernarg_size 88
  .amdhsa_user_sgpr_count 2
  .amdhsa_user_sgpr_kernarg_segment_ptr 1
  .amdhsa_system_sgpr_workgroup_id_x 1
.end_amdhsa_kernel
```
